```python
import torch

def _softmax(x, axis=-1):
    return torch.softmax(x, dim=axis)
def _gelu(x):
    return torch.nn.functional.gelu(x, approximate="tanh")
def _silu(x):
    return torch.nn.functional.silu(x)
def _sigmoid(x):
    return torch.sigmoid(x)
def _layernorm(x, axis=-1, eps=1e-5):
    m = x.mean(dim=axis, keepdim=True)
    v = x.var(dim=axis, keepdim=True, unbiased=False)
    return (x - m) / torch.sqrt(v + eps)
def _scatter_add(tgt, idx, src, axis=0):
    return tgt.clone().index_add_(axis, idx, src)
def _segment_sum(src, seg, n):
    out = torch.zeros((n,) + src.shape[1:], dtype=src.dtype)
    return out.index_add_(0, seg, src)
def _pad(x, pw):
    flat = tuple(v for pair in reversed(pw) for v in pair)
    return torch.nn.functional.pad(x, flat)

kernel_name = 'standalone__kv_cache_quant_int4_int2_kv_with_per_channel_or_per_token_scales__decode'

def setup_inputs():

    _w = (lambda a: (lambda t: t.to(torch.bfloat16) if t.is_floating_point() else t)(torch.as_tensor(a)))
    B = 1
    Sq = 1
    Skv = 32768
    Hq = 32
    Hkv = 32
    Dh = 192
    bits = 3
    G = -1
    if G <= 0 or G >= Skv:
        G = max(1, Skv // 2)
    Skv = (Skv // G) * G
    ngk = Skv // G
    qmax = (1 << bits) - 1
    return {
        "q": _w((lambda *s: torch.randn(*s, dtype=torch.bfloat16) * 3.2)(B, Hq, Sq, Dh)),
        "qk": _w(torch.randint(0, qmax + 1, (B, Hkv, Skv, Dh)).to(torch.int32)),
        "qv": _w(torch.randint(0, qmax + 1, (B, Hkv, Skv, Dh)).to(torch.int32)),
        "k_scales": _w(torch.abs((lambda *s: torch.randn(*s, dtype=torch.bfloat16) * 3.2)(B, Hkv, ngk, Dh)) * 0.05 + 0.02),
        "k_zeros": _w((lambda *s: torch.randn(*s, dtype=torch.bfloat16) * 3.2)(B, Hkv, ngk, Dh) + float(qmax) / 2.0),
        "v_scales": _w(torch.abs((lambda *s: torch.randn(*s, dtype=torch.bfloat16) * 0.05)(B, Hkv, Skv, 1)) * 0.05 + 0.02),
        "v_zeros": _w((lambda *s: torch.randn(*s, dtype=torch.bfloat16) * 0.05)(B, Hkv, Skv, 1) + float(qmax) / 2.0),
    }

def reference(q, qk, qv, k_scales, k_zeros, v_scales, v_zeros):
    B, Hq, Sq, Dh = q.shape
    Hkv, Skv = qk.shape[1], qk.shape[2]
    ngk = k_scales.shape[2]
    G = Skv // ngk
    ks = (lambda x, n, axis: torch.repeat_interleave(x, n, dim=axis))(k_scales, G, axis=2)
    kz = (lambda x, n, axis: torch.repeat_interleave(x, n, dim=axis))(k_zeros, G, axis=2)
    k = ((lambda x, dt: x.to(dt))(qk, q.dtype) - kz) * ks
    v = ((lambda x, dt: x.to(dt))(qv, q.dtype) - v_zeros) * v_scales
    rep = Hq // Hkv
    if rep > 1:
        k = (lambda x, n, axis: torch.repeat_interleave(x, n, dim=axis))(k, rep, axis=1)
        v = (lambda x, n, axis: torch.repeat_interleave(x, n, dim=axis))(v, rep, axis=1)
    scale = float(Dh) ** -0.5
    logits = torch.einsum("bhqd,bhkd->bhqk", q, k) * scale
    p = _softmax(logits, axis=-1)
    o = torch.einsum("bhqk,bhkd->bhqd", p, v)
    return o
```

```asm
; @launch kernel=standalone__kv_cache_quant_int4_int2_kv_with_per_channel_or_per_token_scales__decode_kernel grid=(256,1,1) block=(448,1,1) lds=158272
; @launch kernel=combine_kernel grid=(192,1,1) block=(256,1,1) lds=3200
.amdgcn_target "amdgcn-amd-amdhsa--gfx950"
.text
.globl standalone__kv_cache_quant_int4_int2_kv_with_per_channel_or_per_token_scales__decode_kernel
.p2align 8
.type standalone__kv_cache_quant_int4_int2_kv_with_per_channel_or_per_token_scales__decode_kernel,@function
standalone__kv_cache_quant_int4_int2_kv_with_per_channel_or_per_token_scales__decode_kernel:
    s_cmp_ge_u32 s2, 256
    s_cbranch_scc1 L_end1
    s_load_dwordx4 s[32:35], s[0:1], 0
    s_load_dwordx4 s[36:39], s[0:1], 16
    s_load_dwordx4 s[40:43], s[0:1], 32
    s_load_dwordx2 s[44:45], s[0:1], 48
    s_load_dwordx2 s[82:83], s[0:1], 72
    v_lshrrev_b32 v14, 6, v0
    v_and_b32 v0, 63, v0
    v_readfirstlane_b32 s29, v14
    v_lshrrev_b32 v14, 4, v0
    v_and_b32 v15, 15, v0
    s_cmp_ge_u32 s29, 4
    s_cbranch_scc1 L_aux
    v_mul_u32_u24 v1, 768, v14
    v_lshl_add_u32 v1, v15, 4, v1
    v_lshlrev_b32 v2, 13, v15
    v_lshl_add_u32 v2, v14, 1, v2
    v_lshlrev_b32 v13, 3, v15
    s_and_b32 s27, s2, 7
    s_lshl_b32 s27, s27, 2
    s_bfe_u32 s30, s2, 0x20003
    s_or_b32 s27, s27, s30
    s_and_b32 s30, s2, 0xe0
    s_or_b32 s27, s27, s30
    s_lshl_b32 s78, s27, 2
    s_lshr_b32 s89, s27, 2
    s_and_b32 s89, s89, 15
    s_add_u32 s78, s78, s29
    s_mul_i32 s24, s78, 3072
    s_mov_b32 s25, s24
    s_lshl_b32 s26, s78, 3
    s_lshl_b32 s30, s89, 13
    s_sub_u32 s26, s26, s30
    s_mov_b32 s72, 256
    s_mov_b32 s73, 256
    v_add_u32 v42, s26, v2
    s_waitcnt lgkmcnt(0)
    s_mov_b32 s4, s34
    s_and_b32 s5, s35, 0xffff
    s_mov_b32 s6, 805306368
    s_mov_b32 s7, 0x20000
    s_mov_b32 s8, s36
    s_and_b32 s9, s37, 0xffff
    s_mov_b32 s10, 805306368
    s_mov_b32 s11, 0x20000
    buffer_load_dwordx4 v[52:55], v1, s[4:7], s24 offen offset:0 nt
    buffer_load_dwordx4 v[56:59], v1, s[4:7], s24 offen offset:256 nt
    buffer_load_dwordx4 v[60:63], v1, s[4:7], s24 offen offset:512 nt
    s_sub_u32 s72, s72, 1
    s_add_u32 s24, s24, 3145728
    s_mov_b32 s20, s32
    s_and_b32 s21, s33, 0xffff
    s_mov_b32 s22, 12288
    s_mov_b32 s23, 0x20000
    s_mov_b32 s52, s38
    s_and_b32 s53, s39, 0xffff
    s_mov_b32 s54, 24576
    s_mov_b32 s55, 0x20000
    s_mov_b32 s56, s40
    s_and_b32 s57, s41, 0xffff
    s_mov_b32 s58, 24576
    s_mov_b32 s59, 0x20000
    buffer_load_dwordx2 v[16:17], v13, s[20:23], 0 offen offset:0 nt
    buffer_load_dwordx2 v[18:19], v13, s[20:23], 0 offen offset:128 nt
    buffer_load_dwordx2 v[20:21], v13, s[20:23], 0 offen offset:256 nt
    buffer_load_dwordx2 v[22:23], v13, s[52:55], 0 offen offset:0 nt
    buffer_load_dwordx2 v[24:25], v13, s[52:55], 0 offen offset:128 nt
    buffer_load_dwordx2 v[26:27], v13, s[52:55], 0 offen offset:256 nt
    buffer_load_dwordx2 v[28:29], v13, s[56:59], 0 offen offset:0 nt
    buffer_load_dwordx2 v[30:31], v13, s[56:59], 0 offen offset:128 nt
    buffer_load_dwordx2 v[32:33], v13, s[56:59], 0 offen offset:256 nt
    s_mov_b32 s12, s42
    s_and_b32 s13, s43, 0xffff
    s_mov_b32 s14, 2097152
    s_mov_b32 s15, 0x20000
    s_mov_b32 s16, s44
    s_and_b32 s17, s45, 0xffff
    s_mov_b32 s18, 2097152
    s_mov_b32 s19, 0x20000
    v_mov_b32 v9, 0
    v_mov_b32 v3, 0
    buffer_load_short_d16_hi v9, v42, s[12:15], 0 offen
    buffer_load_short_d16_hi v3, v42, s[16:19], 0 offen
    buffer_load_dwordx4 v[64:67], v1, s[4:7], s24 offen offset:0 nt
    buffer_load_dwordx4 v[68:71], v1, s[4:7], s24 offen offset:256 nt
    buffer_load_dwordx4 v[72:75], v1, s[4:7], s24 offen offset:512 nt
    s_sub_u32 s72, s72, 1
    s_add_u32 s24, s24, 3145728
    s_add_u32 s26, s26, 131072
    s_mov_b32 s74, 0
    s_mov_b32 s79, 0
    s_mov_b32 s86, 0
    s_mov_b32 s84, 0
    s_lshl_b32 s30, s29, 8
    s_add_u32 s30, s30, 50176
    v_lshlrev_b32 v48, 2, v0
    v_add_u32 v48, s30, v48
    v_mov_b32 v49, 51200
    v_mov_b32 v46, 1073741823
    ds_write_b32 v49, v46
    v_lshlrev_b32 v43, 4, v15
    v_add_u32 v43, 52480, v43
    s_lshl_b32 s30, s29, 6
    s_add_u32 s30, s30, 12288
    v_lshlrev_b32 v44, 4, v14
    v_add_u32 v44, s30, v44
    s_mul_i32 s87, s29, 3072
    s_lshl_b32 s30, s29, 12
    s_add_u32 s30, s30, 140800
    v_lshlrev_b32 v82, 2, v14
    v_add_u32 v82, s30, v82
    s_mov_b32 s50, 0x3dd53b95
    v_mov_b32 v40, 0
    v_mov_b32 v41, 0
    s_waitcnt vmcnt(3)
    v_mov_b32 v76, v28
    v_mov_b32 v77, v29
    v_mov_b32 v78, v30
    v_mov_b32 v79, v31
    v_mov_b32 v80, v32
    v_mov_b32 v81, v33
    v_lshlrev_b32 v10, 16, v16
    v_and_b32 v11, 0xffff0000, v16
    v_lshlrev_b32 v12, 16, v22
    v_and_b32 v13, 0xffff0000, v22
    v_mul_f32 v10, s50, v10
    v_mul_f32 v11, s50, v11
    v_lshlrev_b32 v14, 16, v76
    v_and_b32 v15, 0xffff0000, v76
    v_mul_f32 v28, v10, v12
    v_mul_f32 v29, v11, v13
    v_fma_f32 v40, -v28, v14, v40
    v_fma_f32 v41, -v29, v15, v41
    v_lshlrev_b32 v10, 16, v17
    v_and_b32 v11, 0xffff0000, v17
    v_lshlrev_b32 v12, 16, v23
    v_and_b32 v13, 0xffff0000, v23
    v_mul_f32 v10, s50, v10
    v_mul_f32 v11, s50, v11
    v_lshlrev_b32 v14, 16, v77
    v_and_b32 v15, 0xffff0000, v77
    v_mul_f32 v30, v10, v12
    v_mul_f32 v31, v11, v13
    v_fma_f32 v40, -v30, v14, v40
    v_fma_f32 v41, -v31, v15, v41
    v_lshlrev_b32 v10, 16, v18
    v_and_b32 v11, 0xffff0000, v18
    v_lshlrev_b32 v12, 16, v24
    v_and_b32 v13, 0xffff0000, v24
    v_mul_f32 v10, s50, v10
    v_mul_f32 v11, s50, v11
    v_lshlrev_b32 v14, 16, v78
    v_and_b32 v15, 0xffff0000, v78
    v_mul_f32 v32, v10, v12
    v_mul_f32 v33, v11, v13
    v_fma_f32 v40, -v32, v14, v40
    v_fma_f32 v41, -v33, v15, v41
    v_lshlrev_b32 v10, 16, v19
    v_and_b32 v11, 0xffff0000, v19
    v_lshlrev_b32 v12, 16, v25
    v_and_b32 v13, 0xffff0000, v25
    v_mul_f32 v10, s50, v10
    v_mul_f32 v11, s50, v11
    v_lshlrev_b32 v14, 16, v79
    v_and_b32 v15, 0xffff0000, v79
    v_mul_f32 v34, v10, v12
    v_mul_f32 v35, v11, v13
    v_fma_f32 v40, -v34, v14, v40
    v_fma_f32 v41, -v35, v15, v41
    v_lshlrev_b32 v10, 16, v20
    v_and_b32 v11, 0xffff0000, v20
    v_lshlrev_b32 v12, 16, v26
    v_and_b32 v13, 0xffff0000, v26
    v_mul_f32 v10, s50, v10
    v_mul_f32 v11, s50, v11
    v_lshlrev_b32 v14, 16, v80
    v_and_b32 v15, 0xffff0000, v80
    v_mul_f32 v36, v10, v12
    v_mul_f32 v37, v11, v13
    v_fma_f32 v40, -v36, v14, v40
    v_fma_f32 v41, -v37, v15, v41
    v_lshlrev_b32 v10, 16, v21
    v_and_b32 v11, 0xffff0000, v21
    v_lshlrev_b32 v12, 16, v27
    v_and_b32 v13, 0xffff0000, v27
    v_mul_f32 v10, s50, v10
    v_mul_f32 v11, s50, v11
    v_lshlrev_b32 v14, 16, v81
    v_and_b32 v15, 0xffff0000, v81
    v_mul_f32 v38, v10, v12
    v_mul_f32 v39, v11, v13
    v_fma_f32 v40, -v38, v14, v40
    v_fma_f32 v41, -v39, v15, v41
    v_mov_b32 v16, 0
    v_mov_b32 v17, 0
    v_mov_b32 v18, 0
    v_mov_b32 v19, 0
    v_mov_b32 v20, 0
    v_mov_b32 v21, 0
    v_mov_b32 v22, 0
    v_mov_b32 v23, 0
    v_mov_b32 v24, 0
    v_mov_b32 v25, 0
    v_mov_b32 v26, 0
    v_mov_b32 v27, 0
    v_mov_b32 v4, 0xff800000
    v_mov_b32 v5, 0
    v_mov_b32 v6, 0
    s_cmp_eq_u32 s89, 0
    s_cbranch_scc1 L_ph0
    v_mov_b32 v7, v9
    v_mul_f32 v8, v9, v3
    v_add_u32 v42, s26, v2
    s_add_u32 s26, s26, 131072
    buffer_load_short_d16_hi v9, v42, s[12:15], 0 offen
    buffer_load_short_d16_hi v3, v42, s[16:19], 0 offen
    s_mov_b32 s79, 1
    s_mov_b32 s30, s89
L_phr:
    s_sub_u32 s30, s30, 1
    s_cmp_lg_u32 s30, 0
    v_mov_b32_dpp v7, v7 row_ror:15 row_mask:0xf bank_mask:0xf
    v_mov_b32_dpp v8, v8 row_ror:15 row_mask:0xf bank_mask:0xf
    s_cbranch_scc1 L_phr
L_ph0:
L_kloop:
    s_cmp_eq_u32 s74, 127
    s_cselect_b64 s[4:5], s[8:9], s[4:5]
    s_cselect_b32 s24, s25, s24
    s_waitcnt vmcnt(3)
    v_mov_b32 v45, s74
    s_waitcnt lgkmcnt(0)
    v_readfirstlane_b32 s85, v46
    ds_write_b32 v48, v45
    v_cvt_f32_i32 v52, v52
    v_cvt_f32_i32 v53, v53
    v_cvt_f32_i32 v54, v54
    v_cvt_f32_i32 v55, v55
    v_cvt_f32_i32 v56, v56
    v_cvt_f32_i32 v57, v57
    v_cvt_f32_i32 v58, v58
    v_cvt_f32_i32 v59, v59
    v_cvt_f32_i32 v60, v60
    v_cvt_f32_i32 v61, v61
    v_cvt_f32_i32 v62, v62
    v_cvt_f32_i32 v63, v63
    v_pk_fma_f32 v[10:11], v[52:53], v[28:29], v[40:41]
    v_pk_fma_f32 v[10:11], v[54:55], v[30:31], v[10:11]
    v_pk_fma_f32 v[10:11], v[56:57], v[32:33], v[10:11]
    v_pk_fma_f32 v[10:11], v[58:59], v[34:35], v[10:11]
    v_pk_fma_f32 v[10:11], v[60:61], v[36:37], v[10:11]
    v_pk_fma_f32 v[10:11], v[62:63], v[38:39], v[10:11]
    s_lshl_b32 s30, s74, 2
    s_sub_u32 s30, s30, s85
    s_cmp_gt_i32 s30, 20
    s_cbranch_scc1 L_slowa_k
L_slowar_k:
    buffer_load_dwordx4 v[52:55], v1, s[4:7], s24 offen offset:0 nt
    buffer_load_dwordx4 v[56:59], v1, s[4:7], s24 offen offset:256 nt
    buffer_load_dwordx4 v[60:63], v1, s[4:7], s24 offen offset:512 nt
    s_add_u32 s24, s24, 3145728
    v_add_f32 v10, v10, v11
    s_nop 1
    v_add_f32_dpp v10, v10, v10 row_ror:8 row_mask:0xf bank_mask:0xf
    s_nop 1
    v_add_f32_dpp v10, v10, v10 row_ror:4 row_mask:0xf bank_mask:0xf
    s_nop 1
    v_add_f32_dpp v10, v10, v10 row_ror:2 row_mask:0xf bank_mask:0xf
    s_nop 1
    v_add_f32_dpp v10, v10, v10 row_ror:1 row_mask:0xf bank_mask:0xf
    ds_write_b32 v82, v10 offset:0
    s_waitcnt vmcnt(3)
    v_cvt_f32_i32 v64, v64
    v_cvt_f32_i32 v65, v65
    v_cvt_f32_i32 v66, v66
    v_cvt_f32_i32 v67, v67
    v_cvt_f32_i32 v68, v68
    v_cvt_f32_i32 v69, v69
    v_cvt_f32_i32 v70, v70
    v_cvt_f32_i32 v71, v71
    v_cvt_f32_i32 v72, v72
    v_cvt_f32_i32 v73, v73
    v_cvt_f32_i32 v74, v74
    v_cvt_f32_i32 v75, v75
    v_pk_fma_f32 v[80:81], v[64:65], v[28:29], v[40:41]
    v_pk_fma_f32 v[80:81], v[66:67], v[30:31], v[80:81]
    v_pk_fma_f32 v[80:81], v[68:69], v[32:33], v[80:81]
    v_pk_fma_f32 v[80:81], v[70:71], v[34:35], v[80:81]
    v_pk_fma_f32 v[80:81], v[72:73], v[36:37], v[80:81]
    v_pk_fma_f32 v[80:81], v[74:75], v[38:39], v[80:81]
    ds_read2_b32 v[46:47], v49 offset1:2
    s_cmp_eq_u32 s84, 0
    s_cbranch_scc0 L_slowb_k
L_slowbr_k:
    buffer_load_dwordx4 v[64:67], v1, s[4:7], s24 offen offset:0 nt
    buffer_load_dwordx4 v[68:71], v1, s[4:7], s24 offen offset:256 nt
    buffer_load_dwordx4 v[72:75], v1, s[4:7], s24 offen offset:512 nt
    s_add_u32 s24, s24, 3145728
    v_add_f32 v80, v80, v81
    s_add_u32 s74, s74, 1
    s_and_b32 s30, s74, 1
    s_cbranch_scc0 L_tab
L_tabr:
    s_nop 1
    v_add_f32_dpp v80, v80, v80 row_ror:8 row_mask:0xf bank_mask:0xf
    s_nop 1
    v_add_f32_dpp v80, v80, v80 row_ror:4 row_mask:0xf bank_mask:0xf
    s_nop 1
    v_add_f32_dpp v80, v80, v80 row_ror:2 row_mask:0xf bank_mask:0xf
    s_nop 1
    v_add_f32_dpp v80, v80, v80 row_ror:1 row_mask:0xf bank_mask:0xf
    ds_write_b32 v82, v80 offset:16
    v_add_u32 v82, 32, v82
    s_cmp_lt_u32 s74, 128
    s_cbranch_scc1 L_kloop
    v_subrev_u32 v82, 4096, v82
    s_mov_b32 s79, 0
    ds_read2_b32 v[78:79], v82 offset1:4
L_vloop:
    s_cmp_eq_u32 s74, 255
    s_cselect_b32 s6, 0, s6
    s_cmp_eq_u32 s79, 0
    s_cbranch_scc0 L_xw_0
    s_waitcnt vmcnt(3)
L_xwr_0:
    s_and_b32 s30, s89, 15
    s_cbranch_scc0 L_tile_0
L_tiler_0:
    v_mov_b32 v45, s74
    s_waitcnt lgkmcnt(0)
    v_readfirstlane_b32 s85, v46
    ds_write_b32 v48, v45
    v_cmp_gt_f32 vcc, v78, v4
    v_cvt_f32_i32 v52, v52
    v_cvt_f32_i32 v53, v53
    v_cvt_f32_i32 v54, v54
    v_cvt_f32_i32 v55, v55
    s_add_u32 s89, s89, 1
    s_cbranch_vccnz L_resc_0
L_rescr_0:
    v_sub_f32 v14, v78, v4
    v_exp_f32 v14, v14
    v_cvt_f32_i32 v56, v56
    v_cvt_f32_i32 v57, v57
    v_cvt_f32_i32 v58, v58
    v_cvt_f32_i32 v59, v59
    v_cvt_f32_i32 v60, v60
    v_cvt_f32_i32 v61, v61
    v_cvt_f32_i32 v62, v62
    v_cvt_f32_i32 v63, v63
    v_add_f32 v5, v5, v14
    v_mul_f32_dpp v12, v7, v14 row_newbcast:0 row_mask:0xf bank_mask:0xf
    v_fmac_f32_dpp v6, v8, v14 row_newbcast:0 row_mask:0xf bank_mask:0xf
    v_mov_b32_dpp v7, v7 row_ror:15 row_mask:0xf bank_mask:0xf
    v_mov_b32_dpp v8, v8 row_ror:15 row_mask:0xf bank_mask:0xf
    v_pk_fma_f32 v[16:17], v[52:53], v[12:13], v[16:17] op_sel_hi:[1,0,1]
    v_pk_fma_f32 v[18:19], v[54:55], v[12:13], v[18:19] op_sel_hi:[1,0,1]
    v_pk_fma_f32 v[20:21], v[56:57], v[12:13], v[20:21] op_sel_hi:[1,0,1]
    v_pk_fma_f32 v[22:23], v[58:59], v[12:13], v[22:23] op_sel_hi:[1,0,1]
    v_pk_fma_f32 v[24:25], v[60:61], v[12:13], v[24:25] op_sel_hi:[1,0,1]
    v_pk_fma_f32 v[26:27], v[62:63], v[12:13], v[26:27] op_sel_hi:[1,0,1]
    s_lshl_b32 s30, s74, 2
    s_sub_u32 s30, s30, s85
    s_cmp_gt_i32 s30, 20
    s_cbranch_scc1 L_slowa_v
L_slowar_v:
    buffer_load_dwordx4 v[52:55], v1, s[4:7], s24 offen offset:0 nt
    buffer_load_dwordx4 v[56:59], v1, s[4:7], s24 offen offset:256 nt
    buffer_load_dwordx4 v[60:63], v1, s[4:7], s24 offen offset:512 nt
    s_add_u32 s24, s24, 3145728
    s_cmp_eq_u32 s79, 0
    s_cbranch_scc0 L_xw_1
    s_waitcnt vmcnt(3)
L_xwr_1:
    s_and_b32 s30, s89, 15
    s_cbranch_scc0 L_tile_1
L_tiler_1:
    v_cmp_gt_f32 vcc, v79, v4
    v_cvt_f32_i32 v64, v64
    v_cvt_f32_i32 v65, v65
    v_cvt_f32_i32 v66, v66
    v_cvt_f32_i32 v67, v67
    s_add_u32 s89, s89, 1
    s_cbranch_vccnz L_resc_1
L_rescr_1:
    v_sub_f32 v14, v79, v4
    v_exp_f32 v14, v14
    v_add_u32 v82, 32, v82
    v_cvt_f32_i32 v68, v68
    v_cvt_f32_i32 v69, v69
    v_cvt_f32_i32 v70, v70
    v_cvt_f32_i32 v71, v71
    v_cvt_f32_i32 v72, v72
    v_cvt_f32_i32 v73, v73
    v_cvt_f32_i32 v74, v74
    v_cvt_f32_i32 v75, v75
    v_add_f32 v5, v5, v14
    v_mul_f32_dpp v12, v7, v14 row_newbcast:0 row_mask:0xf bank_mask:0xf
    v_fmac_f32_dpp v6, v8, v14 row_newbcast:0 row_mask:0xf bank_mask:0xf
    v_mov_b32_dpp v7, v7 row_ror:15 row_mask:0xf bank_mask:0xf
    v_mov_b32_dpp v8, v8 row_ror:15 row_mask:0xf bank_mask:0xf
    v_pk_fma_f32 v[16:17], v[64:65], v[12:13], v[16:17] op_sel_hi:[1,0,1]
    v_pk_fma_f32 v[18:19], v[66:67], v[12:13], v[18:19] op_sel_hi:[1,0,1]
    v_pk_fma_f32 v[20:21], v[68:69], v[12:13], v[20:21] op_sel_hi:[1,0,1]
    v_pk_fma_f32 v[22:23], v[70:71], v[12:13], v[22:23] op_sel_hi:[1,0,1]
    v_pk_fma_f32 v[24:25], v[72:73], v[12:13], v[24:25] op_sel_hi:[1,0,1]
    v_pk_fma_f32 v[26:27], v[74:75], v[12:13], v[26:27] op_sel_hi:[1,0,1]
    ds_read2_b32 v[46:47], v49 offset1:2
    ds_read2_b32 v[78:79], v82 offset1:4
    s_cmp_eq_u32 s84, 0
    s_cbranch_scc0 L_slowb_v
L_slowbr_v:
    buffer_load_dwordx4 v[64:67], v1, s[4:7], s24 offen offset:0 nt
    buffer_load_dwordx4 v[68:71], v1, s[4:7], s24 offen offset:256 nt
    buffer_load_dwordx4 v[72:75], v1, s[4:7], s24 offen offset:512 nt
    s_add_u32 s24, s24, 3145728
    s_add_u32 s74, s74, 1
    s_and_b32 s30, s74, 3
    s_cbranch_scc0 L_fl
L_flr:
    s_cmp_lt_u32 s74, 256
    s_cbranch_scc1 L_vloop
L_done:
    v_mov_b32 v45, 256
    ds_write_b32 v48, v45
    s_waitcnt vmcnt(0) lgkmcnt(0)
L_end1:
    s_endpgm
L_slowa_k:
    s_waitcnt vmcnt(0)
    s_mov_b32 s84, 1
    s_branch L_slowar_k
L_slowb_k:
    s_waitcnt vmcnt(0)
    s_mov_b32 s84, 0
    s_branch L_slowbr_k
L_tab:
    s_cmp_lg_u32 s74, 2
    s_cbranch_scc1 L_tabn
    s_waitcnt lgkmcnt(0)
    s_barrier
L_tabn:
    s_cmp_lg_u32 s74, 64
    s_cbranch_scc1 L_tabm
L_tabw:
    ds_read2_b32 v[46:47], v49 offset1:2
    s_waitcnt lgkmcnt(0)
    v_readfirstlane_b32 s30, v47
    s_cmp_lt_i32 s30, 0
    s_cbranch_scc1 L_tabw
L_tabm:
    ds_read_b128 v[28:31], v43 offset:0
    ds_read_b128 v[32:35], v43 offset:256
    ds_read_b128 v[36:39], v43 offset:512
    ds_read_b64 v[40:41], v43 offset:768
    v_add_u32 v43, 1024, v43
    s_branch L_tabr
L_xw_0:
    s_waitcnt vmcnt(5)
    s_mov_b32 s79, 0
    s_branch L_xwr_0
L_tile_0:
    v_mov_b32 v7, v9
    v_mul_f32 v8, v9, v3
    v_add_u32 v42, s26, v2
    s_add_u32 s26, s26, 131072
    buffer_load_short_d16_hi v9, v42, s[12:15], 0 offen
    buffer_load_short_d16_hi v3, v42, s[16:19], 0 offen
    s_mov_b32 s79, 1
    s_branch L_tiler_0
L_resc_0:
    v_max_f32 v14, v78, v4
    v_sub_f32 v15, v4, v14
    v_exp_f32 v12, v15
    v_mov_b32 v4, v14
    v_pk_mul_f32 v[16:17], v[16:17], v[12:13] op_sel_hi:[1,0]
    v_pk_mul_f32 v[18:19], v[18:19], v[12:13] op_sel_hi:[1,0]
    v_pk_mul_f32 v[20:21], v[20:21], v[12:13] op_sel_hi:[1,0]
    v_pk_mul_f32 v[22:23], v[22:23], v[12:13] op_sel_hi:[1,0]
    v_pk_mul_f32 v[24:25], v[24:25], v[12:13] op_sel_hi:[1,0]
    v_pk_mul_f32 v[26:27], v[26:27], v[12:13] op_sel_hi:[1,0]
    v_mul_f32 v5, v5, v12
    v_mul_f32 v6, v6, v12
    s_branch L_rescr_0
L_slowa_v:
    s_waitcnt vmcnt(0)
    s_mov_b32 s84, 1
    s_branch L_slowar_v
L_xw_1:
    s_waitcnt vmcnt(5)
    s_mov_b32 s79, 0
    s_branch L_xwr_1
L_tile_1:
    v_mov_b32 v7, v9
    v_mul_f32 v8, v9, v3
    v_add_u32 v42, s26, v2
    s_add_u32 s26, s26, 131072
    buffer_load_short_d16_hi v9, v42, s[12:15], 0 offen
    buffer_load_short_d16_hi v3, v42, s[16:19], 0 offen
    s_mov_b32 s79, 1
    s_branch L_tiler_1
L_resc_1:
    v_max_f32 v14, v79, v4
    v_sub_f32 v15, v4, v14
    v_exp_f32 v12, v15
    v_mov_b32 v4, v14
    v_pk_mul_f32 v[16:17], v[16:17], v[12:13] op_sel_hi:[1,0]
    v_pk_mul_f32 v[18:19], v[18:19], v[12:13] op_sel_hi:[1,0]
    v_pk_mul_f32 v[20:21], v[20:21], v[12:13] op_sel_hi:[1,0]
    v_pk_mul_f32 v[22:23], v[22:23], v[12:13] op_sel_hi:[1,0]
    v_pk_mul_f32 v[24:25], v[24:25], v[12:13] op_sel_hi:[1,0]
    v_pk_mul_f32 v[26:27], v[26:27], v[12:13] op_sel_hi:[1,0]
    v_mul_f32 v5, v5, v12
    v_mul_f32 v6, v6, v12
    s_branch L_rescr_1
L_slowb_v:
    s_waitcnt vmcnt(0)
    s_mov_b32 s84, 0
    s_branch L_slowbr_v
L_fl:
    s_lshr_b32 s88, s74, 2
    s_sub_u32 s88, s88, 33
L_flw:
    s_waitcnt lgkmcnt(0)
    v_readfirstlane_b32 s30, v47
    s_add_u32 s30, s30, 4
    s_cmp_gt_u32 s30, s88
    s_cbranch_scc1 L_flg
    ds_read2_b32 v[46:47], v49 offset1:2
    s_branch L_flw
L_flg:
    s_and_b32 s88, s88, 3
    s_mul_i32 s88, s88, 12544
    s_add_u32 s30, s88, s87
    v_add_u32 v14, s30, v1
    v_add_u32 v15, s88, v44
    ds_write_b128 v14, v[16:19] offset:0
    ds_write_b128 v14, v[20:23] offset:256
    ds_write_b128 v14, v[24:27] offset:512
    ds_write_b128 v15, v[4:7]
    s_waitcnt lgkmcnt(0)
    v_mov_b32 v16, 0
    v_mov_b32 v17, 0
    v_mov_b32 v18, 0
    v_mov_b32 v19, 0
    v_mov_b32 v20, 0
    v_mov_b32 v21, 0
    v_mov_b32 v22, 0
    v_mov_b32 v23, 0
    v_mov_b32 v24, 0
    v_mov_b32 v25, 0
    v_mov_b32 v26, 0
    v_mov_b32 v27, 0
    v_mov_b32 v4, 0xff800000
    v_mov_b32 v5, 0
    v_mov_b32 v6, 0
    s_branch L_flr
L_aux:
    s_waitcnt lgkmcnt(0)
    s_cmp_eq_u32 s29, 4
    s_cbranch_scc1 L_helper
    s_cmp_eq_u32 s29, 6
    s_cbranch_scc1 L_lead
    s_mov_b32 s20, s32
    s_and_b32 s21, s33, 0xffff
    s_mov_b32 s22, 12288
    s_mov_b32 s23, 0x20000
    s_mov_b32 s52, s38
    s_and_b32 s53, s39, 0xffff
    s_mov_b32 s54, 24576
    s_mov_b32 s55, 0x20000
    s_mov_b32 s56, s40
    s_and_b32 s57, s41, 0xffff
    s_mov_b32 s58, 24576
    s_mov_b32 s59, 0x20000
    v_mul_u32_u24 v1, 384, v14
    v_lshl_add_u32 v1, v15, 3, v1
    v_mul_u32_u24 v2, 768, v14
    v_lshl_add_u32 v2, v15, 3, v2
    v_lshlrev_b32 v3, 11, v14
    v_lshl_add_u32 v3, v15, 4, v3
    v_add_u32 v3, 51456, v3
    s_mov_b32 s50, 0x3dd53b95
    v_mov_b32 v4, 51200
    v_mov_b32 v6, 0
    v_mov_b32 v7, -1
    ds_write2_b32 v4, v6, v7 offset0:1 offset1:2
    s_mov_b32 s30, 0
    s_mov_b32 s31, 0
    buffer_load_dwordx2 v[16:17], v1, s[20:23], s30 offen offset:0 nt
    buffer_load_dwordx2 v[18:19], v1, s[20:23], s30 offen offset:128 nt
    buffer_load_dwordx2 v[20:21], v1, s[20:23], s30 offen offset:256 nt
    buffer_load_dwordx2 v[22:23], v2, s[52:55], s31 offen offset:0 nt
    buffer_load_dwordx2 v[24:25], v2, s[52:55], s31 offen offset:128 nt
    buffer_load_dwordx2 v[26:27], v2, s[52:55], s31 offen offset:256 nt
    buffer_load_dwordx2 v[28:29], v2, s[56:59], s31 offen offset:0 nt
    buffer_load_dwordx2 v[30:31], v2, s[56:59], s31 offen offset:128 nt
    buffer_load_dwordx2 v[32:33], v2, s[56:59], s31 offen offset:256 nt
    buffer_load_dwordx2 v[34:35], v2, s[52:55], s31 offen offset:384 nt
    buffer_load_dwordx2 v[36:37], v2, s[52:55], s31 offen offset:512 nt
    buffer_load_dwordx2 v[38:39], v2, s[52:55], s31 offen offset:640 nt
    buffer_load_dwordx2 v[40:41], v2, s[56:59], s31 offen offset:384 nt
    buffer_load_dwordx2 v[42:43], v2, s[56:59], s31 offen offset:512 nt
    buffer_load_dwordx2 v[44:45], v2, s[56:59], s31 offen offset:640 nt
    s_mov_b32 s30, 1536
    s_mov_b32 s31, 3072
    buffer_load_dwordx2 v[46:47], v1, s[20:23], s30 offen offset:0 nt
    buffer_load_dwordx2 v[48:49], v1, s[20:23], s30 offen offset:128 nt
    buffer_load_dwordx2 v[50:51], v1, s[20:23], s30 offen offset:256 nt
    buffer_load_dwordx2 v[52:53], v2, s[52:55], s31 offen offset:0 nt
    buffer_load_dwordx2 v[54:55], v2, s[52:55], s31 offen offset:128 nt
    buffer_load_dwordx2 v[56:57], v2, s[52:55], s31 offen offset:256 nt
    buffer_load_dwordx2 v[58:59], v2, s[56:59], s31 offen offset:0 nt
    buffer_load_dwordx2 v[60:61], v2, s[56:59], s31 offen offset:128 nt
    buffer_load_dwordx2 v[62:63], v2, s[56:59], s31 offen offset:256 nt
    buffer_load_dwordx2 v[64:65], v2, s[52:55], s31 offen offset:384 nt
    buffer_load_dwordx2 v[66:67], v2, s[52:55], s31 offen offset:512 nt
    buffer_load_dwordx2 v[68:69], v2, s[52:55], s31 offen offset:640 nt
    buffer_load_dwordx2 v[70:71], v2, s[56:59], s31 offen offset:384 nt
    buffer_load_dwordx2 v[72:73], v2, s[56:59], s31 offen offset:512 nt
    buffer_load_dwordx2 v[74:75], v2, s[56:59], s31 offen offset:640 nt
    s_mov_b32 s30, 3072
    s_mov_b32 s31, 6144
    buffer_load_dwordx2 v[76:77], v1, s[20:23], s30 offen offset:0 nt
    buffer_load_dwordx2 v[78:79], v1, s[20:23], s30 offen offset:128 nt
    buffer_load_dwordx2 v[80:81], v1, s[20:23], s30 offen offset:256 nt
    buffer_load_dwordx2 v[82:83], v2, s[52:55], s31 offen offset:0 nt
    buffer_load_dwordx2 v[84:85], v2, s[52:55], s31 offen offset:128 nt
    buffer_load_dwordx2 v[86:87], v2, s[52:55], s31 offen offset:256 nt
    buffer_load_dwordx2 v[88:89], v2, s[56:59], s31 offen offset:0 nt
    buffer_load_dwordx2 v[90:91], v2, s[56:59], s31 offen offset:128 nt
    buffer_load_dwordx2 v[92:93], v2, s[56:59], s31 offen offset:256 nt
    buffer_load_dwordx2 v[94:95], v2, s[52:55], s31 offen offset:384 nt
    buffer_load_dwordx2 v[96:97], v2, s[52:55], s31 offen offset:512 nt
    buffer_load_dwordx2 v[98:99], v2, s[52:55], s31 offen offset:640 nt
    buffer_load_dwordx2 v[100:101], v2, s[56:59], s31 offen offset:384 nt
    buffer_load_dwordx2 v[102:103], v2, s[56:59], s31 offen offset:512 nt
    buffer_load_dwordx2 v[104:105], v2, s[56:59], s31 offen offset:640 nt
    s_mov_b32 s30, 4608
    s_mov_b32 s31, 9216
    buffer_load_dwordx2 v[106:107], v1, s[20:23], s30 offen offset:0 nt
    buffer_load_dwordx2 v[108:109], v1, s[20:23], s30 offen offset:128 nt
    buffer_load_dwordx2 v[110:111], v1, s[20:23], s30 offen offset:256 nt
    buffer_load_dwordx2 v[112:113], v2, s[52:55], s31 offen offset:0 nt
    buffer_load_dwordx2 v[114:115], v2, s[52:55], s31 offen offset:128 nt
    buffer_load_dwordx2 v[116:117], v2, s[52:55], s31 offen offset:256 nt
    buffer_load_dwordx2 v[118:119], v2, s[56:59], s31 offen offset:0 nt
    buffer_load_dwordx2 v[120:121], v2, s[56:59], s31 offen offset:128 nt
    buffer_load_dwordx2 v[122:123], v2, s[56:59], s31 offen offset:256 nt
    buffer_load_dwordx2 v[124:125], v2, s[52:55], s31 offen offset:384 nt
    buffer_load_dwordx2 v[126:127], v2, s[52:55], s31 offen offset:512 nt
    buffer_load_dwordx2 v[128:129], v2, s[52:55], s31 offen offset:640 nt
    buffer_load_dwordx2 v[130:131], v2, s[56:59], s31 offen offset:384 nt
    buffer_load_dwordx2 v[132:133], v2, s[56:59], s31 offen offset:512 nt
    buffer_load_dwordx2 v[134:135], v2, s[56:59], s31 offen offset:640 nt
    s_waitcnt vmcnt(45)
    s_waitcnt lgkmcnt(0)
    v_mov_b32 v148, 0
    v_mov_b32 v149, 0
    v_lshlrev_b32 v10, 16, v16
    v_and_b32 v11, 0xffff0000, v16
    v_lshlrev_b32 v12, 16, v22
    v_and_b32 v13, 0xffff0000, v22
    v_mul_f32 v10, s50, v10
    v_mul_f32 v11, s50, v11
    v_lshlrev_b32 v14, 16, v28
    v_and_b32 v15, 0xffff0000, v28
    v_mul_f32 v136, v10, v12
    v_mul_f32 v137, v11, v13
    v_fma_f32 v148, -v136, v14, v148
    v_fma_f32 v149, -v137, v15, v149
    v_lshlrev_b32 v10, 16, v17
    v_and_b32 v11, 0xffff0000, v17
    v_lshlrev_b32 v12, 16, v23
    v_and_b32 v13, 0xffff0000, v23
    v_mul_f32 v10, s50, v10
    v_mul_f32 v11, s50, v11
    v_lshlrev_b32 v14, 16, v29
    v_and_b32 v15, 0xffff0000, v29
    v_mul_f32 v138, v10, v12
    v_mul_f32 v139, v11, v13
    v_fma_f32 v148, -v138, v14, v148
    v_fma_f32 v149, -v139, v15, v149
    v_lshlrev_b32 v10, 16, v18
    v_and_b32 v11, 0xffff0000, v18
    v_lshlrev_b32 v12, 16, v24
    v_and_b32 v13, 0xffff0000, v24
    v_mul_f32 v10, s50, v10
    v_mul_f32 v11, s50, v11
    v_lshlrev_b32 v14, 16, v30
    v_and_b32 v15, 0xffff0000, v30
    v_mul_f32 v140, v10, v12
    v_mul_f32 v141, v11, v13
    v_fma_f32 v148, -v140, v14, v148
    v_fma_f32 v149, -v141, v15, v149
    v_lshlrev_b32 v10, 16, v19
    v_and_b32 v11, 0xffff0000, v19
    v_lshlrev_b32 v12, 16, v25
    v_and_b32 v13, 0xffff0000, v25
    v_mul_f32 v10, s50, v10
    v_mul_f32 v11, s50, v11
    v_lshlrev_b32 v14, 16, v31
    v_and_b32 v15, 0xffff0000, v31
    v_mul_f32 v142, v10, v12
    v_mul_f32 v143, v11, v13
    v_fma_f32 v148, -v142, v14, v148
    v_fma_f32 v149, -v143, v15, v149
    v_lshlrev_b32 v10, 16, v20
    v_and_b32 v11, 0xffff0000, v20
    v_lshlrev_b32 v12, 16, v26
    v_and_b32 v13, 0xffff0000, v26
    v_mul_f32 v10, s50, v10
    v_mul_f32 v11, s50, v11
    v_lshlrev_b32 v14, 16, v32
    v_and_b32 v15, 0xffff0000, v32
    v_mul_f32 v144, v10, v12
    v_mul_f32 v145, v11, v13
    v_fma_f32 v148, -v144, v14, v148
    v_fma_f32 v149, -v145, v15, v149
    v_lshlrev_b32 v10, 16, v21
    v_and_b32 v11, 0xffff0000, v21
    v_lshlrev_b32 v12, 16, v27
    v_and_b32 v13, 0xffff0000, v27
    v_mul_f32 v10, s50, v10
    v_mul_f32 v11, s50, v11
    v_lshlrev_b32 v14, 16, v33
    v_and_b32 v15, 0xffff0000, v33
    v_mul_f32 v146, v10, v12
    v_mul_f32 v147, v11, v13
    v_fma_f32 v148, -v146, v14, v148
    v_fma_f32 v149, -v147, v15, v149
    ds_write_b128 v3, v[136:139] offset:0
    ds_write_b128 v3, v[140:143] offset:256
    ds_write_b128 v3, v[144:147] offset:512
    ds_write_b64 v3, v[148:149] offset:768
    s_waitcnt lgkmcnt(0)
    v_mov_b32 v148, 0
    v_mov_b32 v149, 0
    v_lshlrev_b32 v10, 16, v16
    v_and_b32 v11, 0xffff0000, v16
    v_lshlrev_b32 v12, 16, v34
    v_and_b32 v13, 0xffff0000, v34
    v_mul_f32 v10, s50, v10
    v_mul_f32 v11, s50, v11
    v_lshlrev_b32 v14, 16, v40
    v_and_b32 v15, 0xffff0000, v40
    v_mul_f32 v136, v10, v12
    v_mul_f32 v137, v11, v13
    v_fma_f32 v148, -v136, v14, v148
    v_fma_f32 v149, -v137, v15, v149
    v_lshlrev_b32 v10, 16, v17
    v_and_b32 v11, 0xffff0000, v17
    v_lshlrev_b32 v12, 16, v35
    v_and_b32 v13, 0xffff0000, v35
    v_mul_f32 v10, s50, v10
    v_mul_f32 v11, s50, v11
    v_lshlrev_b32 v14, 16, v41
    v_and_b32 v15, 0xffff0000, v41
    v_mul_f32 v138, v10, v12
    v_mul_f32 v139, v11, v13
    v_fma_f32 v148, -v138, v14, v148
    v_fma_f32 v149, -v139, v15, v149
    v_lshlrev_b32 v10, 16, v18
    v_and_b32 v11, 0xffff0000, v18
    v_lshlrev_b32 v12, 16, v36
    v_and_b32 v13, 0xffff0000, v36
    v_mul_f32 v10, s50, v10
    v_mul_f32 v11, s50, v11
    v_lshlrev_b32 v14, 16, v42
    v_and_b32 v15, 0xffff0000, v42
    v_mul_f32 v140, v10, v12
    v_mul_f32 v141, v11, v13
    v_fma_f32 v148, -v140, v14, v148
    v_fma_f32 v149, -v141, v15, v149
    v_lshlrev_b32 v10, 16, v19
    v_and_b32 v11, 0xffff0000, v19
    v_lshlrev_b32 v12, 16, v37
    v_and_b32 v13, 0xffff0000, v37
    v_mul_f32 v10, s50, v10
    v_mul_f32 v11, s50, v11
    v_lshlrev_b32 v14, 16, v43
    v_and_b32 v15, 0xffff0000, v43
    v_mul_f32 v142, v10, v12
    v_mul_f32 v143, v11, v13
    v_fma_f32 v148, -v142, v14, v148
    v_fma_f32 v149, -v143, v15, v149
    v_lshlrev_b32 v10, 16, v20
    v_and_b32 v11, 0xffff0000, v20
    v_lshlrev_b32 v12, 16, v38
    v_and_b32 v13, 0xffff0000, v38
    v_mul_f32 v10, s50, v10
    v_mul_f32 v11, s50, v11
    v_lshlrev_b32 v14, 16, v44
    v_and_b32 v15, 0xffff0000, v44
    v_mul_f32 v144, v10, v12
    v_mul_f32 v145, v11, v13
    v_fma_f32 v148, -v144, v14, v148
    v_fma_f32 v149, -v145, v15, v149
    v_lshlrev_b32 v10, 16, v21
    v_and_b32 v11, 0xffff0000, v21
    v_lshlrev_b32 v12, 16, v39
    v_and_b32 v13, 0xffff0000, v39
    v_mul_f32 v10, s50, v10
    v_mul_f32 v11, s50, v11
    v_lshlrev_b32 v14, 16, v45
    v_and_b32 v15, 0xffff0000, v45
    v_mul_f32 v146, v10, v12
    v_mul_f32 v147, v11, v13
    v_fma_f32 v148, -v146, v14, v148
    v_fma_f32 v149, -v147, v15, v149
    ds_write_b128 v3, v[136:139] offset:1024
    ds_write_b128 v3, v[140:143] offset:1280
    ds_write_b128 v3, v[144:147] offset:1536
    ds_write_b64 v3, v[148:149] offset:1792
    s_waitcnt vmcnt(30)
    s_waitcnt lgkmcnt(0)
    v_mov_b32 v148, 0
    v_mov_b32 v149, 0
    v_lshlrev_b32 v10, 16, v46
    v_and_b32 v11, 0xffff0000, v46
    v_lshlrev_b32 v12, 16, v52
    v_and_b32 v13, 0xffff0000, v52
    v_mul_f32 v10, s50, v10
    v_mul_f32 v11, s50, v11
    v_lshlrev_b32 v14, 16, v58
    v_and_b32 v15, 0xffff0000, v58
    v_mul_f32 v136, v10, v12
    v_mul_f32 v137, v11, v13
    v_fma_f32 v148, -v136, v14, v148
    v_fma_f32 v149, -v137, v15, v149
    v_lshlrev_b32 v10, 16, v47
    v_and_b32 v11, 0xffff0000, v47
    v_lshlrev_b32 v12, 16, v53
    v_and_b32 v13, 0xffff0000, v53
    v_mul_f32 v10, s50, v10
    v_mul_f32 v11, s50, v11
    v_lshlrev_b32 v14, 16, v59
    v_and_b32 v15, 0xffff0000, v59
    v_mul_f32 v138, v10, v12
    v_mul_f32 v139, v11, v13
    v_fma_f32 v148, -v138, v14, v148
    v_fma_f32 v149, -v139, v15, v149
    v_lshlrev_b32 v10, 16, v48
    v_and_b32 v11, 0xffff0000, v48
    v_lshlrev_b32 v12, 16, v54
    v_and_b32 v13, 0xffff0000, v54
    v_mul_f32 v10, s50, v10
    v_mul_f32 v11, s50, v11
    v_lshlrev_b32 v14, 16, v60
    v_and_b32 v15, 0xffff0000, v60
    v_mul_f32 v140, v10, v12
    v_mul_f32 v141, v11, v13
    v_fma_f32 v148, -v140, v14, v148
    v_fma_f32 v149, -v141, v15, v149
    v_lshlrev_b32 v10, 16, v49
    v_and_b32 v11, 0xffff0000, v49
    v_lshlrev_b32 v12, 16, v55
    v_and_b32 v13, 0xffff0000, v55
    v_mul_f32 v10, s50, v10
    v_mul_f32 v11, s50, v11
    v_lshlrev_b32 v14, 16, v61
    v_and_b32 v15, 0xffff0000, v61
    v_mul_f32 v142, v10, v12
    v_mul_f32 v143, v11, v13
    v_fma_f32 v148, -v142, v14, v148
    v_fma_f32 v149, -v143, v15, v149
    v_lshlrev_b32 v10, 16, v50
    v_and_b32 v11, 0xffff0000, v50
    v_lshlrev_b32 v12, 16, v56
    v_and_b32 v13, 0xffff0000, v56
    v_mul_f32 v10, s50, v10
    v_mul_f32 v11, s50, v11
    v_lshlrev_b32 v14, 16, v62
    v_and_b32 v15, 0xffff0000, v62
    v_mul_f32 v144, v10, v12
    v_mul_f32 v145, v11, v13
    v_fma_f32 v148, -v144, v14, v148
    v_fma_f32 v149, -v145, v15, v149
    v_lshlrev_b32 v10, 16, v51
    v_and_b32 v11, 0xffff0000, v51
    v_lshlrev_b32 v12, 16, v57
    v_and_b32 v13, 0xffff0000, v57
    v_mul_f32 v10, s50, v10
    v_mul_f32 v11, s50, v11
    v_lshlrev_b32 v14, 16, v63
    v_and_b32 v15, 0xffff0000, v63
    v_mul_f32 v146, v10, v12
    v_mul_f32 v147, v11, v13
    v_fma_f32 v148, -v146, v14, v148
    v_fma_f32 v149, -v147, v15, v149
    ds_write_b128 v3, v[136:139] offset:8192
    ds_write_b128 v3, v[140:143] offset:8448
    ds_write_b128 v3, v[144:147] offset:8704
    ds_write_b64 v3, v[148:149] offset:8960
    s_waitcnt lgkmcnt(0)
    v_mov_b32 v148, 0
    v_mov_b32 v149, 0
    v_lshlrev_b32 v10, 16, v46
    v_and_b32 v11, 0xffff0000, v46
    v_lshlrev_b32 v12, 16, v64
    v_and_b32 v13, 0xffff0000, v64
    v_mul_f32 v10, s50, v10
    v_mul_f32 v11, s50, v11
    v_lshlrev_b32 v14, 16, v70
    v_and_b32 v15, 0xffff0000, v70
    v_mul_f32 v136, v10, v12
    v_mul_f32 v137, v11, v13
    v_fma_f32 v148, -v136, v14, v148
    v_fma_f32 v149, -v137, v15, v149
    v_lshlrev_b32 v10, 16, v47
    v_and_b32 v11, 0xffff0000, v47
    v_lshlrev_b32 v12, 16, v65
    v_and_b32 v13, 0xffff0000, v65
    v_mul_f32 v10, s50, v10
    v_mul_f32 v11, s50, v11
    v_lshlrev_b32 v14, 16, v71
    v_and_b32 v15, 0xffff0000, v71
    v_mul_f32 v138, v10, v12
    v_mul_f32 v139, v11, v13
    v_fma_f32 v148, -v138, v14, v148
    v_fma_f32 v149, -v139, v15, v149
    v_lshlrev_b32 v10, 16, v48
    v_and_b32 v11, 0xffff0000, v48
    v_lshlrev_b32 v12, 16, v66
    v_and_b32 v13, 0xffff0000, v66
    v_mul_f32 v10, s50, v10
    v_mul_f32 v11, s50, v11
    v_lshlrev_b32 v14, 16, v72
    v_and_b32 v15, 0xffff0000, v72
    v_mul_f32 v140, v10, v12
    v_mul_f32 v141, v11, v13
    v_fma_f32 v148, -v140, v14, v148
    v_fma_f32 v149, -v141, v15, v149
    v_lshlrev_b32 v10, 16, v49
    v_and_b32 v11, 0xffff0000, v49
    v_lshlrev_b32 v12, 16, v67
    v_and_b32 v13, 0xffff0000, v67
    v_mul_f32 v10, s50, v10
    v_mul_f32 v11, s50, v11
    v_lshlrev_b32 v14, 16, v73
    v_and_b32 v15, 0xffff0000, v73
    v_mul_f32 v142, v10, v12
    v_mul_f32 v143, v11, v13
    v_fma_f32 v148, -v142, v14, v148
    v_fma_f32 v149, -v143, v15, v149
    v_lshlrev_b32 v10, 16, v50
    v_and_b32 v11, 0xffff0000, v50
    v_lshlrev_b32 v12, 16, v68
    v_and_b32 v13, 0xffff0000, v68
    v_mul_f32 v10, s50, v10
    v_mul_f32 v11, s50, v11
    v_lshlrev_b32 v14, 16, v74
    v_and_b32 v15, 0xffff0000, v74
    v_mul_f32 v144, v10, v12
    v_mul_f32 v145, v11, v13
    v_fma_f32 v148, -v144, v14, v148
    v_fma_f32 v149, -v145, v15, v149
    v_lshlrev_b32 v10, 16, v51
    v_and_b32 v11, 0xffff0000, v51
    v_lshlrev_b32 v12, 16, v69
    v_and_b32 v13, 0xffff0000, v69
    v_mul_f32 v10, s50, v10
    v_mul_f32 v11, s50, v11
    v_lshlrev_b32 v14, 16, v75
    v_and_b32 v15, 0xffff0000, v75
    v_mul_f32 v146, v10, v12
    v_mul_f32 v147, v11, v13
    v_fma_f32 v148, -v146, v14, v148
    v_fma_f32 v149, -v147, v15, v149
    ds_write_b128 v3, v[136:139] offset:9216
    ds_write_b128 v3, v[140:143] offset:9472
    ds_write_b128 v3, v[144:147] offset:9728
    ds_write_b64 v3, v[148:149] offset:9984
    s_waitcnt vmcnt(15)
    s_waitcnt lgkmcnt(0)
    v_mov_b32 v148, 0
    v_mov_b32 v149, 0
    v_lshlrev_b32 v10, 16, v76
    v_and_b32 v11, 0xffff0000, v76
    v_lshlrev_b32 v12, 16, v82
    v_and_b32 v13, 0xffff0000, v82
    v_mul_f32 v10, s50, v10
    v_mul_f32 v11, s50, v11
    v_lshlrev_b32 v14, 16, v88
    v_and_b32 v15, 0xffff0000, v88
    v_mul_f32 v136, v10, v12
    v_mul_f32 v137, v11, v13
    v_fma_f32 v148, -v136, v14, v148
    v_fma_f32 v149, -v137, v15, v149
    v_lshlrev_b32 v10, 16, v77
    v_and_b32 v11, 0xffff0000, v77
    v_lshlrev_b32 v12, 16, v83
    v_and_b32 v13, 0xffff0000, v83
    v_mul_f32 v10, s50, v10
    v_mul_f32 v11, s50, v11
    v_lshlrev_b32 v14, 16, v89
    v_and_b32 v15, 0xffff0000, v89
    v_mul_f32 v138, v10, v12
    v_mul_f32 v139, v11, v13
    v_fma_f32 v148, -v138, v14, v148
    v_fma_f32 v149, -v139, v15, v149
    v_lshlrev_b32 v10, 16, v78
    v_and_b32 v11, 0xffff0000, v78
    v_lshlrev_b32 v12, 16, v84
    v_and_b32 v13, 0xffff0000, v84
    v_mul_f32 v10, s50, v10
    v_mul_f32 v11, s50, v11
    v_lshlrev_b32 v14, 16, v90
    v_and_b32 v15, 0xffff0000, v90
    v_mul_f32 v140, v10, v12
    v_mul_f32 v141, v11, v13
    v_fma_f32 v148, -v140, v14, v148
    v_fma_f32 v149, -v141, v15, v149
    v_lshlrev_b32 v10, 16, v79
    v_and_b32 v11, 0xffff0000, v79
    v_lshlrev_b32 v12, 16, v85
    v_and_b32 v13, 0xffff0000, v85
    v_mul_f32 v10, s50, v10
    v_mul_f32 v11, s50, v11
    v_lshlrev_b32 v14, 16, v91
    v_and_b32 v15, 0xffff0000, v91
    v_mul_f32 v142, v10, v12
    v_mul_f32 v143, v11, v13
    v_fma_f32 v148, -v142, v14, v148
    v_fma_f32 v149, -v143, v15, v149
    v_lshlrev_b32 v10, 16, v80
    v_and_b32 v11, 0xffff0000, v80
    v_lshlrev_b32 v12, 16, v86
    v_and_b32 v13, 0xffff0000, v86
    v_mul_f32 v10, s50, v10
    v_mul_f32 v11, s50, v11
    v_lshlrev_b32 v14, 16, v92
    v_and_b32 v15, 0xffff0000, v92
    v_mul_f32 v144, v10, v12
    v_mul_f32 v145, v11, v13
    v_fma_f32 v148, -v144, v14, v148
    v_fma_f32 v149, -v145, v15, v149
    v_lshlrev_b32 v10, 16, v81
    v_and_b32 v11, 0xffff0000, v81
    v_lshlrev_b32 v12, 16, v87
    v_and_b32 v13, 0xffff0000, v87
    v_mul_f32 v10, s50, v10
    v_mul_f32 v11, s50, v11
    v_lshlrev_b32 v14, 16, v93
    v_and_b32 v15, 0xffff0000, v93
    v_mul_f32 v146, v10, v12
    v_mul_f32 v147, v11, v13
    v_fma_f32 v148, -v146, v14, v148
    v_fma_f32 v149, -v147, v15, v149
    ds_write_b128 v3, v[136:139] offset:16384
    ds_write_b128 v3, v[140:143] offset:16640
    ds_write_b128 v3, v[144:147] offset:16896
    ds_write_b64 v3, v[148:149] offset:17152
    s_waitcnt lgkmcnt(0)
    v_mov_b32 v148, 0
    v_mov_b32 v149, 0
    v_lshlrev_b32 v10, 16, v76
    v_and_b32 v11, 0xffff0000, v76
    v_lshlrev_b32 v12, 16, v94
    v_and_b32 v13, 0xffff0000, v94
    v_mul_f32 v10, s50, v10
    v_mul_f32 v11, s50, v11
    v_lshlrev_b32 v14, 16, v100
    v_and_b32 v15, 0xffff0000, v100
    v_mul_f32 v136, v10, v12
    v_mul_f32 v137, v11, v13
    v_fma_f32 v148, -v136, v14, v148
    v_fma_f32 v149, -v137, v15, v149
    v_lshlrev_b32 v10, 16, v77
    v_and_b32 v11, 0xffff0000, v77
    v_lshlrev_b32 v12, 16, v95
    v_and_b32 v13, 0xffff0000, v95
    v_mul_f32 v10, s50, v10
    v_mul_f32 v11, s50, v11
    v_lshlrev_b32 v14, 16, v101
    v_and_b32 v15, 0xffff0000, v101
    v_mul_f32 v138, v10, v12
    v_mul_f32 v139, v11, v13
    v_fma_f32 v148, -v138, v14, v148
    v_fma_f32 v149, -v139, v15, v149
    v_lshlrev_b32 v10, 16, v78
    v_and_b32 v11, 0xffff0000, v78
    v_lshlrev_b32 v12, 16, v96
    v_and_b32 v13, 0xffff0000, v96
    v_mul_f32 v10, s50, v10
    v_mul_f32 v11, s50, v11
    v_lshlrev_b32 v14, 16, v102
    v_and_b32 v15, 0xffff0000, v102
    v_mul_f32 v140, v10, v12
    v_mul_f32 v141, v11, v13
    v_fma_f32 v148, -v140, v14, v148
    v_fma_f32 v149, -v141, v15, v149
    v_lshlrev_b32 v10, 16, v79
    v_and_b32 v11, 0xffff0000, v79
    v_lshlrev_b32 v12, 16, v97
    v_and_b32 v13, 0xffff0000, v97
    v_mul_f32 v10, s50, v10
    v_mul_f32 v11, s50, v11
    v_lshlrev_b32 v14, 16, v103
    v_and_b32 v15, 0xffff0000, v103
    v_mul_f32 v142, v10, v12
    v_mul_f32 v143, v11, v13
    v_fma_f32 v148, -v142, v14, v148
    v_fma_f32 v149, -v143, v15, v149
    v_lshlrev_b32 v10, 16, v80
    v_and_b32 v11, 0xffff0000, v80
    v_lshlrev_b32 v12, 16, v98
    v_and_b32 v13, 0xffff0000, v98
    v_mul_f32 v10, s50, v10
    v_mul_f32 v11, s50, v11
    v_lshlrev_b32 v14, 16, v104
    v_and_b32 v15, 0xffff0000, v104
    v_mul_f32 v144, v10, v12
    v_mul_f32 v145, v11, v13
    v_fma_f32 v148, -v144, v14, v148
    v_fma_f32 v149, -v145, v15, v149
    v_lshlrev_b32 v10, 16, v81
    v_and_b32 v11, 0xffff0000, v81
    v_lshlrev_b32 v12, 16, v99
    v_and_b32 v13, 0xffff0000, v99
    v_mul_f32 v10, s50, v10
    v_mul_f32 v11, s50, v11
    v_lshlrev_b32 v14, 16, v105
    v_and_b32 v15, 0xffff0000, v105
    v_mul_f32 v146, v10, v12
    v_mul_f32 v147, v11, v13
    v_fma_f32 v148, -v146, v14, v148
    v_fma_f32 v149, -v147, v15, v149
    ds_write_b128 v3, v[136:139] offset:17408
    ds_write_b128 v3, v[140:143] offset:17664
    ds_write_b128 v3, v[144:147] offset:17920
    ds_write_b64 v3, v[148:149] offset:18176
    s_waitcnt vmcnt(0)
    s_waitcnt lgkmcnt(0)
    v_mov_b32 v148, 0
    v_mov_b32 v149, 0
    v_lshlrev_b32 v10, 16, v106
    v_and_b32 v11, 0xffff0000, v106
    v_lshlrev_b32 v12, 16, v112
    v_and_b32 v13, 0xffff0000, v112
    v_mul_f32 v10, s50, v10
    v_mul_f32 v11, s50, v11
    v_lshlrev_b32 v14, 16, v118
    v_and_b32 v15, 0xffff0000, v118
    v_mul_f32 v136, v10, v12
    v_mul_f32 v137, v11, v13
    v_fma_f32 v148, -v136, v14, v148
    v_fma_f32 v149, -v137, v15, v149
    v_lshlrev_b32 v10, 16, v107
    v_and_b32 v11, 0xffff0000, v107
    v_lshlrev_b32 v12, 16, v113
    v_and_b32 v13, 0xffff0000, v113
    v_mul_f32 v10, s50, v10
    v_mul_f32 v11, s50, v11
    v_lshlrev_b32 v14, 16, v119
    v_and_b32 v15, 0xffff0000, v119
    v_mul_f32 v138, v10, v12
    v_mul_f32 v139, v11, v13
    v_fma_f32 v148, -v138, v14, v148
    v_fma_f32 v149, -v139, v15, v149
    v_lshlrev_b32 v10, 16, v108
    v_and_b32 v11, 0xffff0000, v108
    v_lshlrev_b32 v12, 16, v114
    v_and_b32 v13, 0xffff0000, v114
    v_mul_f32 v10, s50, v10
    v_mul_f32 v11, s50, v11
    v_lshlrev_b32 v14, 16, v120
    v_and_b32 v15, 0xffff0000, v120
    v_mul_f32 v140, v10, v12
    v_mul_f32 v141, v11, v13
    v_fma_f32 v148, -v140, v14, v148
    v_fma_f32 v149, -v141, v15, v149
    v_lshlrev_b32 v10, 16, v109
    v_and_b32 v11, 0xffff0000, v109
    v_lshlrev_b32 v12, 16, v115
    v_and_b32 v13, 0xffff0000, v115
    v_mul_f32 v10, s50, v10
    v_mul_f32 v11, s50, v11
    v_lshlrev_b32 v14, 16, v121
    v_and_b32 v15, 0xffff0000, v121
    v_mul_f32 v142, v10, v12
    v_mul_f32 v143, v11, v13
    v_fma_f32 v148, -v142, v14, v148
    v_fma_f32 v149, -v143, v15, v149
    v_lshlrev_b32 v10, 16, v110
    v_and_b32 v11, 0xffff0000, v110
    v_lshlrev_b32 v12, 16, v116
    v_and_b32 v13, 0xffff0000, v116
    v_mul_f32 v10, s50, v10
    v_mul_f32 v11, s50, v11
    v_lshlrev_b32 v14, 16, v122
    v_and_b32 v15, 0xffff0000, v122
    v_mul_f32 v144, v10, v12
    v_mul_f32 v145, v11, v13
    v_fma_f32 v148, -v144, v14, v148
    v_fma_f32 v149, -v145, v15, v149
    v_lshlrev_b32 v10, 16, v111
    v_and_b32 v11, 0xffff0000, v111
    v_lshlrev_b32 v12, 16, v117
    v_and_b32 v13, 0xffff0000, v117
    v_mul_f32 v10, s50, v10
    v_mul_f32 v11, s50, v11
    v_lshlrev_b32 v14, 16, v123
    v_and_b32 v15, 0xffff0000, v123
    v_mul_f32 v146, v10, v12
    v_mul_f32 v147, v11, v13
    v_fma_f32 v148, -v146, v14, v148
    v_fma_f32 v149, -v147, v15, v149
    ds_write_b128 v3, v[136:139] offset:24576
    ds_write_b128 v3, v[140:143] offset:24832
    ds_write_b128 v3, v[144:147] offset:25088
    ds_write_b64 v3, v[148:149] offset:25344
    s_waitcnt lgkmcnt(0)
    v_mov_b32 v148, 0
    v_mov_b32 v149, 0
    v_lshlrev_b32 v10, 16, v106
    v_and_b32 v11, 0xffff0000, v106
    v_lshlrev_b32 v12, 16, v124
    v_and_b32 v13, 0xffff0000, v124
    v_mul_f32 v10, s50, v10
    v_mul_f32 v11, s50, v11
    v_lshlrev_b32 v14, 16, v130
    v_and_b32 v15, 0xffff0000, v130
    v_mul_f32 v136, v10, v12
    v_mul_f32 v137, v11, v13
    v_fma_f32 v148, -v136, v14, v148
    v_fma_f32 v149, -v137, v15, v149
    v_lshlrev_b32 v10, 16, v107
    v_and_b32 v11, 0xffff0000, v107
    v_lshlrev_b32 v12, 16, v125
    v_and_b32 v13, 0xffff0000, v125
    v_mul_f32 v10, s50, v10
    v_mul_f32 v11, s50, v11
    v_lshlrev_b32 v14, 16, v131
    v_and_b32 v15, 0xffff0000, v131
    v_mul_f32 v138, v10, v12
    v_mul_f32 v139, v11, v13
    v_fma_f32 v148, -v138, v14, v148
    v_fma_f32 v149, -v139, v15, v149
    v_lshlrev_b32 v10, 16, v108
    v_and_b32 v11, 0xffff0000, v108
    v_lshlrev_b32 v12, 16, v126
    v_and_b32 v13, 0xffff0000, v126
    v_mul_f32 v10, s50, v10
    v_mul_f32 v11, s50, v11
    v_lshlrev_b32 v14, 16, v132
    v_and_b32 v15, 0xffff0000, v132
    v_mul_f32 v140, v10, v12
    v_mul_f32 v141, v11, v13
    v_fma_f32 v148, -v140, v14, v148
    v_fma_f32 v149, -v141, v15, v149
    v_lshlrev_b32 v10, 16, v109
    v_and_b32 v11, 0xffff0000, v109
    v_lshlrev_b32 v12, 16, v127
    v_and_b32 v13, 0xffff0000, v127
    v_mul_f32 v10, s50, v10
    v_mul_f32 v11, s50, v11
    v_lshlrev_b32 v14, 16, v133
    v_and_b32 v15, 0xffff0000, v133
    v_mul_f32 v142, v10, v12
    v_mul_f32 v143, v11, v13
    v_fma_f32 v148, -v142, v14, v148
    v_fma_f32 v149, -v143, v15, v149
    v_lshlrev_b32 v10, 16, v110
    v_and_b32 v11, 0xffff0000, v110
    v_lshlrev_b32 v12, 16, v128
    v_and_b32 v13, 0xffff0000, v128
    v_mul_f32 v10, s50, v10
    v_mul_f32 v11, s50, v11
    v_lshlrev_b32 v14, 16, v134
    v_and_b32 v15, 0xffff0000, v134
    v_mul_f32 v144, v10, v12
    v_mul_f32 v145, v11, v13
    v_fma_f32 v148, -v144, v14, v148
    v_fma_f32 v149, -v145, v15, v149
    v_lshlrev_b32 v10, 16, v111
    v_and_b32 v11, 0xffff0000, v111
    v_lshlrev_b32 v12, 16, v129
    v_and_b32 v13, 0xffff0000, v129
    v_mul_f32 v10, s50, v10
    v_mul_f32 v11, s50, v11
    v_lshlrev_b32 v14, 16, v135
    v_and_b32 v15, 0xffff0000, v135
    v_mul_f32 v146, v10, v12
    v_mul_f32 v147, v11, v13
    v_fma_f32 v148, -v146, v14, v148
    v_fma_f32 v149, -v147, v15, v149
    ds_write_b128 v3, v[136:139] offset:25600
    ds_write_b128 v3, v[140:143] offset:25856
    ds_write_b128 v3, v[144:147] offset:26112
    ds_write_b64 v3, v[148:149] offset:26368
    s_waitcnt lgkmcnt(0)
    s_barrier
    s_mov_b32 s30, 6144
    s_mov_b32 s31, 12288
    buffer_load_dwordx2 v[16:17], v1, s[20:23], s30 offen offset:0 nt
    buffer_load_dwordx2 v[18:19], v1, s[20:23], s30 offen offset:128 nt
    buffer_load_dwordx2 v[20:21], v1, s[20:23], s30 offen offset:256 nt
    buffer_load_dwordx2 v[22:23], v2, s[52:55], s31 offen offset:0 nt
    buffer_load_dwordx2 v[24:25], v2, s[52:55], s31 offen offset:128 nt
    buffer_load_dwordx2 v[26:27], v2, s[52:55], s31 offen offset:256 nt
    buffer_load_dwordx2 v[28:29], v2, s[56:59], s31 offen offset:0 nt
    buffer_load_dwordx2 v[30:31], v2, s[56:59], s31 offen offset:128 nt
    buffer_load_dwordx2 v[32:33], v2, s[56:59], s31 offen offset:256 nt
    buffer_load_dwordx2 v[34:35], v2, s[52:55], s31 offen offset:384 nt
    buffer_load_dwordx2 v[36:37], v2, s[52:55], s31 offen offset:512 nt
    buffer_load_dwordx2 v[38:39], v2, s[52:55], s31 offen offset:640 nt
    buffer_load_dwordx2 v[40:41], v2, s[56:59], s31 offen offset:384 nt
    buffer_load_dwordx2 v[42:43], v2, s[56:59], s31 offen offset:512 nt
    buffer_load_dwordx2 v[44:45], v2, s[56:59], s31 offen offset:640 nt
    s_mov_b32 s30, 7680
    s_mov_b32 s31, 15360
    buffer_load_dwordx2 v[46:47], v1, s[20:23], s30 offen offset:0 nt
    buffer_load_dwordx2 v[48:49], v1, s[20:23], s30 offen offset:128 nt
    buffer_load_dwordx2 v[50:51], v1, s[20:23], s30 offen offset:256 nt
    buffer_load_dwordx2 v[52:53], v2, s[52:55], s31 offen offset:0 nt
    buffer_load_dwordx2 v[54:55], v2, s[52:55], s31 offen offset:128 nt
    buffer_load_dwordx2 v[56:57], v2, s[52:55], s31 offen offset:256 nt
    buffer_load_dwordx2 v[58:59], v2, s[56:59], s31 offen offset:0 nt
    buffer_load_dwordx2 v[60:61], v2, s[56:59], s31 offen offset:128 nt
    buffer_load_dwordx2 v[62:63], v2, s[56:59], s31 offen offset:256 nt
    buffer_load_dwordx2 v[64:65], v2, s[52:55], s31 offen offset:384 nt
    buffer_load_dwordx2 v[66:67], v2, s[52:55], s31 offen offset:512 nt
    buffer_load_dwordx2 v[68:69], v2, s[52:55], s31 offen offset:640 nt
    buffer_load_dwordx2 v[70:71], v2, s[56:59], s31 offen offset:384 nt
    buffer_load_dwordx2 v[72:73], v2, s[56:59], s31 offen offset:512 nt
    buffer_load_dwordx2 v[74:75], v2, s[56:59], s31 offen offset:640 nt
    s_mov_b32 s30, 9216
    s_mov_b32 s31, 18432
    buffer_load_dwordx2 v[76:77], v1, s[20:23], s30 offen offset:0 nt
    buffer_load_dwordx2 v[78:79], v1, s[20:23], s30 offen offset:128 nt
    buffer_load_dwordx2 v[80:81], v1, s[20:23], s30 offen offset:256 nt
    buffer_load_dwordx2 v[82:83], v2, s[52:55], s31 offen offset:0 nt
    buffer_load_dwordx2 v[84:85], v2, s[52:55], s31 offen offset:128 nt
    buffer_load_dwordx2 v[86:87], v2, s[52:55], s31 offen offset:256 nt
    buffer_load_dwordx2 v[88:89], v2, s[56:59], s31 offen offset:0 nt
    buffer_load_dwordx2 v[90:91], v2, s[56:59], s31 offen offset:128 nt
    buffer_load_dwordx2 v[92:93], v2, s[56:59], s31 offen offset:256 nt
    buffer_load_dwordx2 v[94:95], v2, s[52:55], s31 offen offset:384 nt
    buffer_load_dwordx2 v[96:97], v2, s[52:55], s31 offen offset:512 nt
    buffer_load_dwordx2 v[98:99], v2, s[52:55], s31 offen offset:640 nt
    buffer_load_dwordx2 v[100:101], v2, s[56:59], s31 offen offset:384 nt
    buffer_load_dwordx2 v[102:103], v2, s[56:59], s31 offen offset:512 nt
    buffer_load_dwordx2 v[104:105], v2, s[56:59], s31 offen offset:640 nt
    s_mov_b32 s30, 10752
    s_mov_b32 s31, 21504
    buffer_load_dwordx2 v[106:107], v1, s[20:23], s30 offen offset:0 nt
    buffer_load_dwordx2 v[108:109], v1, s[20:23], s30 offen offset:128 nt
    buffer_load_dwordx2 v[110:111], v1, s[20:23], s30 offen offset:256 nt
    buffer_load_dwordx2 v[112:113], v2, s[52:55], s31 offen offset:0 nt
    buffer_load_dwordx2 v[114:115], v2, s[52:55], s31 offen offset:128 nt
    buffer_load_dwordx2 v[116:117], v2, s[52:55], s31 offen offset:256 nt
    buffer_load_dwordx2 v[118:119], v2, s[56:59], s31 offen offset:0 nt
    buffer_load_dwordx2 v[120:121], v2, s[56:59], s31 offen offset:128 nt
    buffer_load_dwordx2 v[122:123], v2, s[56:59], s31 offen offset:256 nt
    buffer_load_dwordx2 v[124:125], v2, s[52:55], s31 offen offset:384 nt
    buffer_load_dwordx2 v[126:127], v2, s[52:55], s31 offen offset:512 nt
    buffer_load_dwordx2 v[128:129], v2, s[52:55], s31 offen offset:640 nt
    buffer_load_dwordx2 v[130:131], v2, s[56:59], s31 offen offset:384 nt
    buffer_load_dwordx2 v[132:133], v2, s[56:59], s31 offen offset:512 nt
    buffer_load_dwordx2 v[134:135], v2, s[56:59], s31 offen offset:640 nt
    s_waitcnt vmcnt(45)
    s_waitcnt lgkmcnt(0)
    v_mov_b32 v148, 0
    v_mov_b32 v149, 0
    v_lshlrev_b32 v10, 16, v16
    v_and_b32 v11, 0xffff0000, v16
    v_lshlrev_b32 v12, 16, v22
    v_and_b32 v13, 0xffff0000, v22
    v_mul_f32 v10, s50, v10
    v_mul_f32 v11, s50, v11
    v_lshlrev_b32 v14, 16, v28
    v_and_b32 v15, 0xffff0000, v28
    v_mul_f32 v136, v10, v12
    v_mul_f32 v137, v11, v13
    v_fma_f32 v148, -v136, v14, v148
    v_fma_f32 v149, -v137, v15, v149
    v_lshlrev_b32 v10, 16, v17
    v_and_b32 v11, 0xffff0000, v17
    v_lshlrev_b32 v12, 16, v23
    v_and_b32 v13, 0xffff0000, v23
    v_mul_f32 v10, s50, v10
    v_mul_f32 v11, s50, v11
    v_lshlrev_b32 v14, 16, v29
    v_and_b32 v15, 0xffff0000, v29
    v_mul_f32 v138, v10, v12
    v_mul_f32 v139, v11, v13
    v_fma_f32 v148, -v138, v14, v148
    v_fma_f32 v149, -v139, v15, v149
    v_lshlrev_b32 v10, 16, v18
    v_and_b32 v11, 0xffff0000, v18
    v_lshlrev_b32 v12, 16, v24
    v_and_b32 v13, 0xffff0000, v24
    v_mul_f32 v10, s50, v10
    v_mul_f32 v11, s50, v11
    v_lshlrev_b32 v14, 16, v30
    v_and_b32 v15, 0xffff0000, v30
    v_mul_f32 v140, v10, v12
    v_mul_f32 v141, v11, v13
    v_fma_f32 v148, -v140, v14, v148
    v_fma_f32 v149, -v141, v15, v149
    v_lshlrev_b32 v10, 16, v19
    v_and_b32 v11, 0xffff0000, v19
    v_lshlrev_b32 v12, 16, v25
    v_and_b32 v13, 0xffff0000, v25
    v_mul_f32 v10, s50, v10
    v_mul_f32 v11, s50, v11
    v_lshlrev_b32 v14, 16, v31
    v_and_b32 v15, 0xffff0000, v31
    v_mul_f32 v142, v10, v12
    v_mul_f32 v143, v11, v13
    v_fma_f32 v148, -v142, v14, v148
    v_fma_f32 v149, -v143, v15, v149
    v_lshlrev_b32 v10, 16, v20
    v_and_b32 v11, 0xffff0000, v20
    v_lshlrev_b32 v12, 16, v26
    v_and_b32 v13, 0xffff0000, v26
    v_mul_f32 v10, s50, v10
    v_mul_f32 v11, s50, v11
    v_lshlrev_b32 v14, 16, v32
    v_and_b32 v15, 0xffff0000, v32
    v_mul_f32 v144, v10, v12
    v_mul_f32 v145, v11, v13
    v_fma_f32 v148, -v144, v14, v148
    v_fma_f32 v149, -v145, v15, v149
    v_lshlrev_b32 v10, 16, v21
    v_and_b32 v11, 0xffff0000, v21
    v_lshlrev_b32 v12, 16, v27
    v_and_b32 v13, 0xffff0000, v27
    v_mul_f32 v10, s50, v10
    v_mul_f32 v11, s50, v11
    v_lshlrev_b32 v14, 16, v33
    v_and_b32 v15, 0xffff0000, v33
    v_mul_f32 v146, v10, v12
    v_mul_f32 v147, v11, v13
    v_fma_f32 v148, -v146, v14, v148
    v_fma_f32 v149, -v147, v15, v149
    ds_write_b128 v3, v[136:139] offset:32768
    ds_write_b128 v3, v[140:143] offset:33024
    ds_write_b128 v3, v[144:147] offset:33280
    ds_write_b64 v3, v[148:149] offset:33536
    s_waitcnt lgkmcnt(0)
    v_mov_b32 v148, 0
    v_mov_b32 v149, 0
    v_lshlrev_b32 v10, 16, v16
    v_and_b32 v11, 0xffff0000, v16
    v_lshlrev_b32 v12, 16, v34
    v_and_b32 v13, 0xffff0000, v34
    v_mul_f32 v10, s50, v10
    v_mul_f32 v11, s50, v11
    v_lshlrev_b32 v14, 16, v40
    v_and_b32 v15, 0xffff0000, v40
    v_mul_f32 v136, v10, v12
    v_mul_f32 v137, v11, v13
    v_fma_f32 v148, -v136, v14, v148
    v_fma_f32 v149, -v137, v15, v149
    v_lshlrev_b32 v10, 16, v17
    v_and_b32 v11, 0xffff0000, v17
    v_lshlrev_b32 v12, 16, v35
    v_and_b32 v13, 0xffff0000, v35
    v_mul_f32 v10, s50, v10
    v_mul_f32 v11, s50, v11
    v_lshlrev_b32 v14, 16, v41
    v_and_b32 v15, 0xffff0000, v41
    v_mul_f32 v138, v10, v12
    v_mul_f32 v139, v11, v13
    v_fma_f32 v148, -v138, v14, v148
    v_fma_f32 v149, -v139, v15, v149
    v_lshlrev_b32 v10, 16, v18
    v_and_b32 v11, 0xffff0000, v18
    v_lshlrev_b32 v12, 16, v36
    v_and_b32 v13, 0xffff0000, v36
    v_mul_f32 v10, s50, v10
    v_mul_f32 v11, s50, v11
    v_lshlrev_b32 v14, 16, v42
    v_and_b32 v15, 0xffff0000, v42
    v_mul_f32 v140, v10, v12
    v_mul_f32 v141, v11, v13
    v_fma_f32 v148, -v140, v14, v148
    v_fma_f32 v149, -v141, v15, v149
    v_lshlrev_b32 v10, 16, v19
    v_and_b32 v11, 0xffff0000, v19
    v_lshlrev_b32 v12, 16, v37
    v_and_b32 v13, 0xffff0000, v37
    v_mul_f32 v10, s50, v10
    v_mul_f32 v11, s50, v11
    v_lshlrev_b32 v14, 16, v43
    v_and_b32 v15, 0xffff0000, v43
    v_mul_f32 v142, v10, v12
    v_mul_f32 v143, v11, v13
    v_fma_f32 v148, -v142, v14, v148
    v_fma_f32 v149, -v143, v15, v149
    v_lshlrev_b32 v10, 16, v20
    v_and_b32 v11, 0xffff0000, v20
    v_lshlrev_b32 v12, 16, v38
    v_and_b32 v13, 0xffff0000, v38
    v_mul_f32 v10, s50, v10
    v_mul_f32 v11, s50, v11
    v_lshlrev_b32 v14, 16, v44
    v_and_b32 v15, 0xffff0000, v44
    v_mul_f32 v144, v10, v12
    v_mul_f32 v145, v11, v13
    v_fma_f32 v148, -v144, v14, v148
    v_fma_f32 v149, -v145, v15, v149
    v_lshlrev_b32 v10, 16, v21
    v_and_b32 v11, 0xffff0000, v21
    v_lshlrev_b32 v12, 16, v39
    v_and_b32 v13, 0xffff0000, v39
    v_mul_f32 v10, s50, v10
    v_mul_f32 v11, s50, v11
    v_lshlrev_b32 v14, 16, v45
    v_and_b32 v15, 0xffff0000, v45
    v_mul_f32 v146, v10, v12
    v_mul_f32 v147, v11, v13
    v_fma_f32 v148, -v146, v14, v148
    v_fma_f32 v149, -v147, v15, v149
    ds_write_b128 v3, v[136:139] offset:33792
    ds_write_b128 v3, v[140:143] offset:34048
    ds_write_b128 v3, v[144:147] offset:34304
    ds_write_b64 v3, v[148:149] offset:34560
    s_waitcnt vmcnt(30)
    s_waitcnt lgkmcnt(0)
    v_mov_b32 v148, 0
    v_mov_b32 v149, 0
    v_lshlrev_b32 v10, 16, v46
    v_and_b32 v11, 0xffff0000, v46
    v_lshlrev_b32 v12, 16, v52
    v_and_b32 v13, 0xffff0000, v52
    v_mul_f32 v10, s50, v10
    v_mul_f32 v11, s50, v11
    v_lshlrev_b32 v14, 16, v58
    v_and_b32 v15, 0xffff0000, v58
    v_mul_f32 v136, v10, v12
    v_mul_f32 v137, v11, v13
    v_fma_f32 v148, -v136, v14, v148
    v_fma_f32 v149, -v137, v15, v149
    v_lshlrev_b32 v10, 16, v47
    v_and_b32 v11, 0xffff0000, v47
    v_lshlrev_b32 v12, 16, v53
    v_and_b32 v13, 0xffff0000, v53
    v_mul_f32 v10, s50, v10
    v_mul_f32 v11, s50, v11
    v_lshlrev_b32 v14, 16, v59
    v_and_b32 v15, 0xffff0000, v59
    v_mul_f32 v138, v10, v12
    v_mul_f32 v139, v11, v13
    v_fma_f32 v148, -v138, v14, v148
    v_fma_f32 v149, -v139, v15, v149
    v_lshlrev_b32 v10, 16, v48
    v_and_b32 v11, 0xffff0000, v48
    v_lshlrev_b32 v12, 16, v54
    v_and_b32 v13, 0xffff0000, v54
    v_mul_f32 v10, s50, v10
    v_mul_f32 v11, s50, v11
    v_lshlrev_b32 v14, 16, v60
    v_and_b32 v15, 0xffff0000, v60
    v_mul_f32 v140, v10, v12
    v_mul_f32 v141, v11, v13
    v_fma_f32 v148, -v140, v14, v148
    v_fma_f32 v149, -v141, v15, v149
    v_lshlrev_b32 v10, 16, v49
    v_and_b32 v11, 0xffff0000, v49
    v_lshlrev_b32 v12, 16, v55
    v_and_b32 v13, 0xffff0000, v55
    v_mul_f32 v10, s50, v10
    v_mul_f32 v11, s50, v11
    v_lshlrev_b32 v14, 16, v61
    v_and_b32 v15, 0xffff0000, v61
    v_mul_f32 v142, v10, v12
    v_mul_f32 v143, v11, v13
    v_fma_f32 v148, -v142, v14, v148
    v_fma_f32 v149, -v143, v15, v149
    v_lshlrev_b32 v10, 16, v50
    v_and_b32 v11, 0xffff0000, v50
    v_lshlrev_b32 v12, 16, v56
    v_and_b32 v13, 0xffff0000, v56
    v_mul_f32 v10, s50, v10
    v_mul_f32 v11, s50, v11
    v_lshlrev_b32 v14, 16, v62
    v_and_b32 v15, 0xffff0000, v62
    v_mul_f32 v144, v10, v12
    v_mul_f32 v145, v11, v13
    v_fma_f32 v148, -v144, v14, v148
    v_fma_f32 v149, -v145, v15, v149
    v_lshlrev_b32 v10, 16, v51
    v_and_b32 v11, 0xffff0000, v51
    v_lshlrev_b32 v12, 16, v57
    v_and_b32 v13, 0xffff0000, v57
    v_mul_f32 v10, s50, v10
    v_mul_f32 v11, s50, v11
    v_lshlrev_b32 v14, 16, v63
    v_and_b32 v15, 0xffff0000, v63
    v_mul_f32 v146, v10, v12
    v_mul_f32 v147, v11, v13
    v_fma_f32 v148, -v146, v14, v148
    v_fma_f32 v149, -v147, v15, v149
    ds_write_b128 v3, v[136:139] offset:40960
    ds_write_b128 v3, v[140:143] offset:41216
    ds_write_b128 v3, v[144:147] offset:41472
    ds_write_b64 v3, v[148:149] offset:41728
    s_waitcnt lgkmcnt(0)
    v_mov_b32 v148, 0
    v_mov_b32 v149, 0
    v_lshlrev_b32 v10, 16, v46
    v_and_b32 v11, 0xffff0000, v46
    v_lshlrev_b32 v12, 16, v64
    v_and_b32 v13, 0xffff0000, v64
    v_mul_f32 v10, s50, v10
    v_mul_f32 v11, s50, v11
    v_lshlrev_b32 v14, 16, v70
    v_and_b32 v15, 0xffff0000, v70
    v_mul_f32 v136, v10, v12
    v_mul_f32 v137, v11, v13
    v_fma_f32 v148, -v136, v14, v148
    v_fma_f32 v149, -v137, v15, v149
    v_lshlrev_b32 v10, 16, v47
    v_and_b32 v11, 0xffff0000, v47
    v_lshlrev_b32 v12, 16, v65
    v_and_b32 v13, 0xffff0000, v65
    v_mul_f32 v10, s50, v10
    v_mul_f32 v11, s50, v11
    v_lshlrev_b32 v14, 16, v71
    v_and_b32 v15, 0xffff0000, v71
    v_mul_f32 v138, v10, v12
    v_mul_f32 v139, v11, v13
    v_fma_f32 v148, -v138, v14, v148
    v_fma_f32 v149, -v139, v15, v149
    v_lshlrev_b32 v10, 16, v48
    v_and_b32 v11, 0xffff0000, v48
    v_lshlrev_b32 v12, 16, v66
    v_and_b32 v13, 0xffff0000, v66
    v_mul_f32 v10, s50, v10
    v_mul_f32 v11, s50, v11
    v_lshlrev_b32 v14, 16, v72
    v_and_b32 v15, 0xffff0000, v72
    v_mul_f32 v140, v10, v12
    v_mul_f32 v141, v11, v13
    v_fma_f32 v148, -v140, v14, v148
    v_fma_f32 v149, -v141, v15, v149
    v_lshlrev_b32 v10, 16, v49
    v_and_b32 v11, 0xffff0000, v49
    v_lshlrev_b32 v12, 16, v67
    v_and_b32 v13, 0xffff0000, v67
    v_mul_f32 v10, s50, v10
    v_mul_f32 v11, s50, v11
    v_lshlrev_b32 v14, 16, v73
    v_and_b32 v15, 0xffff0000, v73
    v_mul_f32 v142, v10, v12
    v_mul_f32 v143, v11, v13
    v_fma_f32 v148, -v142, v14, v148
    v_fma_f32 v149, -v143, v15, v149
    v_lshlrev_b32 v10, 16, v50
    v_and_b32 v11, 0xffff0000, v50
    v_lshlrev_b32 v12, 16, v68
    v_and_b32 v13, 0xffff0000, v68
    v_mul_f32 v10, s50, v10
    v_mul_f32 v11, s50, v11
    v_lshlrev_b32 v14, 16, v74
    v_and_b32 v15, 0xffff0000, v74
    v_mul_f32 v144, v10, v12
    v_mul_f32 v145, v11, v13
    v_fma_f32 v148, -v144, v14, v148
    v_fma_f32 v149, -v145, v15, v149
    v_lshlrev_b32 v10, 16, v51
    v_and_b32 v11, 0xffff0000, v51
    v_lshlrev_b32 v12, 16, v69
    v_and_b32 v13, 0xffff0000, v69
    v_mul_f32 v10, s50, v10
    v_mul_f32 v11, s50, v11
    v_lshlrev_b32 v14, 16, v75
    v_and_b32 v15, 0xffff0000, v75
    v_mul_f32 v146, v10, v12
    v_mul_f32 v147, v11, v13
    v_fma_f32 v148, -v146, v14, v148
    v_fma_f32 v149, -v147, v15, v149
    ds_write_b128 v3, v[136:139] offset:41984
    ds_write_b128 v3, v[140:143] offset:42240
    ds_write_b128 v3, v[144:147] offset:42496
    ds_write_b64 v3, v[148:149] offset:42752
    s_waitcnt vmcnt(15)
    s_waitcnt lgkmcnt(0)
    v_mov_b32 v148, 0
    v_mov_b32 v149, 0
    v_lshlrev_b32 v10, 16, v76
    v_and_b32 v11, 0xffff0000, v76
    v_lshlrev_b32 v12, 16, v82
    v_and_b32 v13, 0xffff0000, v82
    v_mul_f32 v10, s50, v10
    v_mul_f32 v11, s50, v11
    v_lshlrev_b32 v14, 16, v88
    v_and_b32 v15, 0xffff0000, v88
    v_mul_f32 v136, v10, v12
    v_mul_f32 v137, v11, v13
    v_fma_f32 v148, -v136, v14, v148
    v_fma_f32 v149, -v137, v15, v149
    v_lshlrev_b32 v10, 16, v77
    v_and_b32 v11, 0xffff0000, v77
    v_lshlrev_b32 v12, 16, v83
    v_and_b32 v13, 0xffff0000, v83
    v_mul_f32 v10, s50, v10
    v_mul_f32 v11, s50, v11
    v_lshlrev_b32 v14, 16, v89
    v_and_b32 v15, 0xffff0000, v89
    v_mul_f32 v138, v10, v12
    v_mul_f32 v139, v11, v13
    v_fma_f32 v148, -v138, v14, v148
    v_fma_f32 v149, -v139, v15, v149
    v_lshlrev_b32 v10, 16, v78
    v_and_b32 v11, 0xffff0000, v78
    v_lshlrev_b32 v12, 16, v84
    v_and_b32 v13, 0xffff0000, v84
    v_mul_f32 v10, s50, v10
    v_mul_f32 v11, s50, v11
    v_lshlrev_b32 v14, 16, v90
    v_and_b32 v15, 0xffff0000, v90
    v_mul_f32 v140, v10, v12
    v_mul_f32 v141, v11, v13
    v_fma_f32 v148, -v140, v14, v148
    v_fma_f32 v149, -v141, v15, v149
    v_lshlrev_b32 v10, 16, v79
    v_and_b32 v11, 0xffff0000, v79
    v_lshlrev_b32 v12, 16, v85
    v_and_b32 v13, 0xffff0000, v85
    v_mul_f32 v10, s50, v10
    v_mul_f32 v11, s50, v11
    v_lshlrev_b32 v14, 16, v91
    v_and_b32 v15, 0xffff0000, v91
    v_mul_f32 v142, v10, v12
    v_mul_f32 v143, v11, v13
    v_fma_f32 v148, -v142, v14, v148
    v_fma_f32 v149, -v143, v15, v149
    v_lshlrev_b32 v10, 16, v80
    v_and_b32 v11, 0xffff0000, v80
    v_lshlrev_b32 v12, 16, v86
    v_and_b32 v13, 0xffff0000, v86
    v_mul_f32 v10, s50, v10
    v_mul_f32 v11, s50, v11
    v_lshlrev_b32 v14, 16, v92
    v_and_b32 v15, 0xffff0000, v92
    v_mul_f32 v144, v10, v12
    v_mul_f32 v145, v11, v13
    v_fma_f32 v148, -v144, v14, v148
    v_fma_f32 v149, -v145, v15, v149
    v_lshlrev_b32 v10, 16, v81
    v_and_b32 v11, 0xffff0000, v81
    v_lshlrev_b32 v12, 16, v87
    v_and_b32 v13, 0xffff0000, v87
    v_mul_f32 v10, s50, v10
    v_mul_f32 v11, s50, v11
    v_lshlrev_b32 v14, 16, v93
    v_and_b32 v15, 0xffff0000, v93
    v_mul_f32 v146, v10, v12
    v_mul_f32 v147, v11, v13
    v_fma_f32 v148, -v146, v14, v148
    v_fma_f32 v149, -v147, v15, v149
    ds_write_b128 v3, v[136:139] offset:49152
    ds_write_b128 v3, v[140:143] offset:49408
    ds_write_b128 v3, v[144:147] offset:49664
    ds_write_b64 v3, v[148:149] offset:49920
    s_waitcnt lgkmcnt(0)
    v_mov_b32 v148, 0
    v_mov_b32 v149, 0
    v_lshlrev_b32 v10, 16, v76
    v_and_b32 v11, 0xffff0000, v76
    v_lshlrev_b32 v12, 16, v94
    v_and_b32 v13, 0xffff0000, v94
    v_mul_f32 v10, s50, v10
    v_mul_f32 v11, s50, v11
    v_lshlrev_b32 v14, 16, v100
    v_and_b32 v15, 0xffff0000, v100
    v_mul_f32 v136, v10, v12
    v_mul_f32 v137, v11, v13
    v_fma_f32 v148, -v136, v14, v148
    v_fma_f32 v149, -v137, v15, v149
    v_lshlrev_b32 v10, 16, v77
    v_and_b32 v11, 0xffff0000, v77
    v_lshlrev_b32 v12, 16, v95
    v_and_b32 v13, 0xffff0000, v95
    v_mul_f32 v10, s50, v10
    v_mul_f32 v11, s50, v11
    v_lshlrev_b32 v14, 16, v101
    v_and_b32 v15, 0xffff0000, v101
    v_mul_f32 v138, v10, v12
    v_mul_f32 v139, v11, v13
    v_fma_f32 v148, -v138, v14, v148
    v_fma_f32 v149, -v139, v15, v149
    v_lshlrev_b32 v10, 16, v78
    v_and_b32 v11, 0xffff0000, v78
    v_lshlrev_b32 v12, 16, v96
    v_and_b32 v13, 0xffff0000, v96
    v_mul_f32 v10, s50, v10
    v_mul_f32 v11, s50, v11
    v_lshlrev_b32 v14, 16, v102
    v_and_b32 v15, 0xffff0000, v102
    v_mul_f32 v140, v10, v12
    v_mul_f32 v141, v11, v13
    v_fma_f32 v148, -v140, v14, v148
    v_fma_f32 v149, -v141, v15, v149
    v_lshlrev_b32 v10, 16, v79
    v_and_b32 v11, 0xffff0000, v79
    v_lshlrev_b32 v12, 16, v97
    v_and_b32 v13, 0xffff0000, v97
    v_mul_f32 v10, s50, v10
    v_mul_f32 v11, s50, v11
    v_lshlrev_b32 v14, 16, v103
    v_and_b32 v15, 0xffff0000, v103
    v_mul_f32 v142, v10, v12
    v_mul_f32 v143, v11, v13
    v_fma_f32 v148, -v142, v14, v148
    v_fma_f32 v149, -v143, v15, v149
    v_lshlrev_b32 v10, 16, v80
    v_and_b32 v11, 0xffff0000, v80
    v_lshlrev_b32 v12, 16, v98
    v_and_b32 v13, 0xffff0000, v98
    v_mul_f32 v10, s50, v10
    v_mul_f32 v11, s50, v11
    v_lshlrev_b32 v14, 16, v104
    v_and_b32 v15, 0xffff0000, v104
    v_mul_f32 v144, v10, v12
    v_mul_f32 v145, v11, v13
    v_fma_f32 v148, -v144, v14, v148
    v_fma_f32 v149, -v145, v15, v149
    v_lshlrev_b32 v10, 16, v81
    v_and_b32 v11, 0xffff0000, v81
    v_lshlrev_b32 v12, 16, v99
    v_and_b32 v13, 0xffff0000, v99
    v_mul_f32 v10, s50, v10
    v_mul_f32 v11, s50, v11
    v_lshlrev_b32 v14, 16, v105
    v_and_b32 v15, 0xffff0000, v105
    v_mul_f32 v146, v10, v12
    v_mul_f32 v147, v11, v13
    v_fma_f32 v148, -v146, v14, v148
    v_fma_f32 v149, -v147, v15, v149
    ds_write_b128 v3, v[136:139] offset:50176
    ds_write_b128 v3, v[140:143] offset:50432
    ds_write_b128 v3, v[144:147] offset:50688
    ds_write_b64 v3, v[148:149] offset:50944
    s_waitcnt vmcnt(0)
    s_waitcnt lgkmcnt(0)
    v_mov_b32 v148, 0
    v_mov_b32 v149, 0
    v_lshlrev_b32 v10, 16, v106
    v_and_b32 v11, 0xffff0000, v106
    v_lshlrev_b32 v12, 16, v112
    v_and_b32 v13, 0xffff0000, v112
    v_mul_f32 v10, s50, v10
    v_mul_f32 v11, s50, v11
    v_lshlrev_b32 v14, 16, v118
    v_and_b32 v15, 0xffff0000, v118
    v_mul_f32 v136, v10, v12
    v_mul_f32 v137, v11, v13
    v_fma_f32 v148, -v136, v14, v148
    v_fma_f32 v149, -v137, v15, v149
    v_lshlrev_b32 v10, 16, v107
    v_and_b32 v11, 0xffff0000, v107
    v_lshlrev_b32 v12, 16, v113
    v_and_b32 v13, 0xffff0000, v113
    v_mul_f32 v10, s50, v10
    v_mul_f32 v11, s50, v11
    v_lshlrev_b32 v14, 16, v119
    v_and_b32 v15, 0xffff0000, v119
    v_mul_f32 v138, v10, v12
    v_mul_f32 v139, v11, v13
    v_fma_f32 v148, -v138, v14, v148
    v_fma_f32 v149, -v139, v15, v149
    v_lshlrev_b32 v10, 16, v108
    v_and_b32 v11, 0xffff0000, v108
    v_lshlrev_b32 v12, 16, v114
    v_and_b32 v13, 0xffff0000, v114
    v_mul_f32 v10, s50, v10
    v_mul_f32 v11, s50, v11
    v_lshlrev_b32 v14, 16, v120
    v_and_b32 v15, 0xffff0000, v120
    v_mul_f32 v140, v10, v12
    v_mul_f32 v141, v11, v13
    v_fma_f32 v148, -v140, v14, v148
    v_fma_f32 v149, -v141, v15, v149
    v_lshlrev_b32 v10, 16, v109
    v_and_b32 v11, 0xffff0000, v109
    v_lshlrev_b32 v12, 16, v115
    v_and_b32 v13, 0xffff0000, v115
    v_mul_f32 v10, s50, v10
    v_mul_f32 v11, s50, v11
    v_lshlrev_b32 v14, 16, v121
    v_and_b32 v15, 0xffff0000, v121
    v_mul_f32 v142, v10, v12
    v_mul_f32 v143, v11, v13
    v_fma_f32 v148, -v142, v14, v148
    v_fma_f32 v149, -v143, v15, v149
    v_lshlrev_b32 v10, 16, v110
    v_and_b32 v11, 0xffff0000, v110
    v_lshlrev_b32 v12, 16, v116
    v_and_b32 v13, 0xffff0000, v116
    v_mul_f32 v10, s50, v10
    v_mul_f32 v11, s50, v11
    v_lshlrev_b32 v14, 16, v122
    v_and_b32 v15, 0xffff0000, v122
    v_mul_f32 v144, v10, v12
    v_mul_f32 v145, v11, v13
    v_fma_f32 v148, -v144, v14, v148
    v_fma_f32 v149, -v145, v15, v149
    v_lshlrev_b32 v10, 16, v111
    v_and_b32 v11, 0xffff0000, v111
    v_lshlrev_b32 v12, 16, v117
    v_and_b32 v13, 0xffff0000, v117
    v_mul_f32 v10, s50, v10
    v_mul_f32 v11, s50, v11
    v_lshlrev_b32 v14, 16, v123
    v_and_b32 v15, 0xffff0000, v123
    v_mul_f32 v146, v10, v12
    v_mul_f32 v147, v11, v13
    v_fma_f32 v148, -v146, v14, v148
    v_fma_f32 v149, -v147, v15, v149
    ds_write_b128 v3, v[136:139] offset:57344
    ds_write_b128 v3, v[140:143] offset:57600
    ds_write_b128 v3, v[144:147] offset:57856
    ds_write_b64 v3, v[148:149] offset:58112
    s_waitcnt lgkmcnt(0)
    v_mov_b32 v148, 0
    v_mov_b32 v149, 0
    v_lshlrev_b32 v10, 16, v106
    v_and_b32 v11, 0xffff0000, v106
    v_lshlrev_b32 v12, 16, v124
    v_and_b32 v13, 0xffff0000, v124
    v_mul_f32 v10, s50, v10
    v_mul_f32 v11, s50, v11
    v_lshlrev_b32 v14, 16, v130
    v_and_b32 v15, 0xffff0000, v130
    v_mul_f32 v136, v10, v12
    v_mul_f32 v137, v11, v13
    v_fma_f32 v148, -v136, v14, v148
    v_fma_f32 v149, -v137, v15, v149
    v_lshlrev_b32 v10, 16, v107
    v_and_b32 v11, 0xffff0000, v107
    v_lshlrev_b32 v12, 16, v125
    v_and_b32 v13, 0xffff0000, v125
    v_mul_f32 v10, s50, v10
    v_mul_f32 v11, s50, v11
    v_lshlrev_b32 v14, 16, v131
    v_and_b32 v15, 0xffff0000, v131
    v_mul_f32 v138, v10, v12
    v_mul_f32 v139, v11, v13
    v_fma_f32 v148, -v138, v14, v148
    v_fma_f32 v149, -v139, v15, v149
    v_lshlrev_b32 v10, 16, v108
    v_and_b32 v11, 0xffff0000, v108
    v_lshlrev_b32 v12, 16, v126
    v_and_b32 v13, 0xffff0000, v126
    v_mul_f32 v10, s50, v10
    v_mul_f32 v11, s50, v11
    v_lshlrev_b32 v14, 16, v132
    v_and_b32 v15, 0xffff0000, v132
    v_mul_f32 v140, v10, v12
    v_mul_f32 v141, v11, v13
    v_fma_f32 v148, -v140, v14, v148
    v_fma_f32 v149, -v141, v15, v149
    v_lshlrev_b32 v10, 16, v109
    v_and_b32 v11, 0xffff0000, v109
    v_lshlrev_b32 v12, 16, v127
    v_and_b32 v13, 0xffff0000, v127
    v_mul_f32 v10, s50, v10
    v_mul_f32 v11, s50, v11
    v_lshlrev_b32 v14, 16, v133
    v_and_b32 v15, 0xffff0000, v133
    v_mul_f32 v142, v10, v12
    v_mul_f32 v143, v11, v13
    v_fma_f32 v148, -v142, v14, v148
    v_fma_f32 v149, -v143, v15, v149
    v_lshlrev_b32 v10, 16, v110
    v_and_b32 v11, 0xffff0000, v110
    v_lshlrev_b32 v12, 16, v128
    v_and_b32 v13, 0xffff0000, v128
    v_mul_f32 v10, s50, v10
    v_mul_f32 v11, s50, v11
    v_lshlrev_b32 v14, 16, v134
    v_and_b32 v15, 0xffff0000, v134
    v_mul_f32 v144, v10, v12
    v_mul_f32 v145, v11, v13
    v_fma_f32 v148, -v144, v14, v148
    v_fma_f32 v149, -v145, v15, v149
    v_lshlrev_b32 v10, 16, v111
    v_and_b32 v11, 0xffff0000, v111
    v_lshlrev_b32 v12, 16, v129
    v_and_b32 v13, 0xffff0000, v129
    v_mul_f32 v10, s50, v10
    v_mul_f32 v11, s50, v11
    v_lshlrev_b32 v14, 16, v135
    v_and_b32 v15, 0xffff0000, v135
    v_mul_f32 v146, v10, v12
    v_mul_f32 v147, v11, v13
    v_fma_f32 v148, -v146, v14, v148
    v_fma_f32 v149, -v147, v15, v149
    ds_write_b128 v3, v[136:139] offset:58368
    ds_write_b128 v3, v[140:143] offset:58624
    ds_write_b128 v3, v[144:147] offset:58880
    ds_write_b64 v3, v[148:149] offset:59136
    s_mov_b32 s20, s82
    s_and_b32 s21, s83, 0xffff
    s_mov_b32 s22, 6356992
    s_mov_b32 s23, 0x20000
    v_min_u32 v6, 3, v0
    v_lshlrev_b32 v6, 8, v6
    v_add_u32 v6, 50176, v6
    v_min_u32 v7, 47, v0
    v_lshlrev_b32 v7, 4, v7
    v_mov_b32 v14, 51200
    v_mov_b32 v12, 0
    v_mov_b32 v13, 0
    s_mov_b32 s34, 0
    s_mov_b32 s35, 132
    s_waitcnt lgkmcnt(0)
    ds_write_b32 v14, v12 offset:8
    s_mul_i32 s33, s2, 24576
    v_add_u32 v150, 116992, v7
L_cw:
    ds_read_b32 v5, v6
    s_waitcnt lgkmcnt(0)
    v_readlane_b32 s36, v5, 0
    v_readlane_b32 s37, v5, 1
    s_min_u32 s36, s36, s37
    v_readlane_b32 s37, v5, 2
    s_min_u32 s36, s36, s37
    v_readlane_b32 s37, v5, 3
    s_min_u32 s36, s36, s37
    s_cmp_lt_u32 s36, s35
    s_cbranch_scc1 L_cw
    s_and_b32 s30, s34, 3
    s_mul_i32 s30, s30, 12544
    v_mov_b32 v2, s30
    v_add_u32 v1, s30, v7
    v_mov_b32 v3, 0xff800000
    ds_read_b128 v[16:19], v2 offset:12288
    ds_read_b128 v[20:23], v2 offset:12304
    ds_read_b128 v[24:27], v2 offset:12320
    ds_read_b128 v[28:31], v2 offset:12336
    ds_read_b128 v[32:35], v2 offset:12352
    ds_read_b128 v[36:39], v2 offset:12368
    ds_read_b128 v[40:43], v2 offset:12384
    ds_read_b128 v[44:47], v2 offset:12400
    ds_read_b128 v[48:51], v2 offset:12416
    ds_read_b128 v[52:55], v2 offset:12432
    ds_read_b128 v[56:59], v2 offset:12448
    ds_read_b128 v[60:63], v2 offset:12464
    ds_read_b128 v[64:67], v2 offset:12480
    ds_read_b128 v[68:71], v2 offset:12496
    ds_read_b128 v[72:75], v2 offset:12512
    ds_read_b128 v[76:79], v2 offset:12528
    ds_read_b128 v[80:83], v1 offset:0
    ds_read_b128 v[84:87], v1 offset:768
    ds_read_b128 v[88:91], v1 offset:1536
    ds_read_b128 v[92:95], v1 offset:2304
    ds_read_b128 v[96:99], v1 offset:3072
    ds_read_b128 v[100:103], v1 offset:3840
    ds_read_b128 v[104:107], v1 offset:4608
    ds_read_b128 v[108:111], v1 offset:5376
    ds_read_b128 v[112:115], v1 offset:6144
    ds_read_b128 v[116:119], v1 offset:6912
    ds_read_b128 v[120:123], v1 offset:7680
    ds_read_b128 v[124:127], v1 offset:8448
    ds_read_b128 v[128:131], v1 offset:9216
    ds_read_b128 v[132:135], v1 offset:9984
    ds_read_b128 v[136:139], v1 offset:10752
    ds_read_b128 v[140:143], v1 offset:11520
    s_waitcnt lgkmcnt(15)
    v_max3_f32 v3, v3, v16, v20
    v_max3_f32 v3, v3, v24, v28
    v_max3_f32 v3, v3, v32, v36
    v_max3_f32 v3, v3, v40, v44
    v_max3_f32 v3, v3, v48, v52
    v_max3_f32 v3, v3, v56, v60
    v_max3_f32 v3, v3, v64, v68
    v_max3_f32 v3, v3, v72, v76
    v_sub_f32 v16, v16, v3
    v_sub_f32 v20, v20, v3
    v_sub_f32 v24, v24, v3
    v_sub_f32 v28, v28, v3
    v_sub_f32 v32, v32, v3
    v_sub_f32 v36, v36, v3
    v_sub_f32 v40, v40, v3
    v_sub_f32 v44, v44, v3
    v_sub_f32 v48, v48, v3
    v_sub_f32 v52, v52, v3
    v_sub_f32 v56, v56, v3
    v_sub_f32 v60, v60, v3
    v_sub_f32 v64, v64, v3
    v_sub_f32 v68, v68, v3
    v_sub_f32 v72, v72, v3
    v_sub_f32 v76, v76, v3
    v_exp_f32 v16, v16
    v_exp_f32 v20, v20
    v_exp_f32 v24, v24
    v_exp_f32 v28, v28
    v_exp_f32 v32, v32
    v_exp_f32 v36, v36
    v_exp_f32 v40, v40
    v_exp_f32 v44, v44
    v_exp_f32 v48, v48
    v_exp_f32 v52, v52
    v_exp_f32 v56, v56
    v_exp_f32 v60, v60
    v_exp_f32 v64, v64
    v_exp_f32 v68, v68
    v_exp_f32 v72, v72
    v_exp_f32 v76, v76
    v_mov_b32 v4, 0
    v_mov_b32 v5, 0
    v_mov_b32 v8, 0
    v_mov_b32 v9, 0
    v_mov_b32 v10, 0
    v_mov_b32 v11, 0
    v_fmac_f32 v4, v16, v17
    v_fmac_f32 v5, v16, v18
    v_fmac_f32 v4, v20, v21
    v_fmac_f32 v5, v20, v22
    v_fmac_f32 v4, v24, v25
    v_fmac_f32 v5, v24, v26
    v_fmac_f32 v4, v28, v29
    v_fmac_f32 v5, v28, v30
    v_fmac_f32 v4, v32, v33
    v_fmac_f32 v5, v32, v34
    v_fmac_f32 v4, v36, v37
    v_fmac_f32 v5, v36, v38
    v_fmac_f32 v4, v40, v41
    v_fmac_f32 v5, v40, v42
    v_fmac_f32 v4, v44, v45
    v_fmac_f32 v5, v44, v46
    v_fmac_f32 v4, v48, v49
    v_fmac_f32 v5, v48, v50
    v_fmac_f32 v4, v52, v53
    v_fmac_f32 v5, v52, v54
    v_fmac_f32 v4, v56, v57
    v_fmac_f32 v5, v56, v58
    v_fmac_f32 v4, v60, v61
    v_fmac_f32 v5, v60, v62
    v_fmac_f32 v4, v64, v65
    v_fmac_f32 v5, v64, v66
    v_fmac_f32 v4, v68, v69
    v_fmac_f32 v5, v68, v70
    v_fmac_f32 v4, v72, v73
    v_fmac_f32 v5, v72, v74
    v_fmac_f32 v4, v76, v77
    v_fmac_f32 v5, v76, v78
    s_add_u32 s31, s34, 1
    v_mov_b32 v15, s31
    s_waitcnt lgkmcnt(0)
    ds_write_b32 v14, v15 offset:8
    v_fmac_f32 v8, v16, v80
    v_fmac_f32 v9, v16, v81
    v_fmac_f32 v10, v16, v82
    v_fmac_f32 v11, v16, v83
    v_fmac_f32 v8, v20, v84
    v_fmac_f32 v9, v20, v85
    v_fmac_f32 v10, v20, v86
    v_fmac_f32 v11, v20, v87
    v_fmac_f32 v8, v24, v88
    v_fmac_f32 v9, v24, v89
    v_fmac_f32 v10, v24, v90
    v_fmac_f32 v11, v24, v91
    v_fmac_f32 v8, v28, v92
    v_fmac_f32 v9, v28, v93
    v_fmac_f32 v10, v28, v94
    v_fmac_f32 v11, v28, v95
    v_fmac_f32 v8, v32, v96
    v_fmac_f32 v9, v32, v97
    v_fmac_f32 v10, v32, v98
    v_fmac_f32 v11, v32, v99
    v_fmac_f32 v8, v36, v100
    v_fmac_f32 v9, v36, v101
    v_fmac_f32 v10, v36, v102
    v_fmac_f32 v11, v36, v103
    v_fmac_f32 v8, v40, v104
    v_fmac_f32 v9, v40, v105
    v_fmac_f32 v10, v40, v106
    v_fmac_f32 v11, v40, v107
    v_fmac_f32 v8, v44, v108
    v_fmac_f32 v9, v44, v109
    v_fmac_f32 v10, v44, v110
    v_fmac_f32 v11, v44, v111
    v_fmac_f32 v8, v48, v112
    v_fmac_f32 v9, v48, v113
    v_fmac_f32 v10, v48, v114
    v_fmac_f32 v11, v48, v115
    v_fmac_f32 v8, v52, v116
    v_fmac_f32 v9, v52, v117
    v_fmac_f32 v10, v52, v118
    v_fmac_f32 v11, v52, v119
    v_fmac_f32 v8, v56, v120
    v_fmac_f32 v9, v56, v121
    v_fmac_f32 v10, v56, v122
    v_fmac_f32 v11, v56, v123
    v_fmac_f32 v8, v60, v124
    v_fmac_f32 v9, v60, v125
    v_fmac_f32 v10, v60, v126
    v_fmac_f32 v11, v60, v127
    v_fmac_f32 v8, v64, v128
    v_fmac_f32 v9, v64, v129
    v_fmac_f32 v10, v64, v130
    v_fmac_f32 v11, v64, v131
    v_fmac_f32 v8, v68, v132
    v_fmac_f32 v9, v68, v133
    v_fmac_f32 v10, v68, v134
    v_fmac_f32 v11, v68, v135
    v_fmac_f32 v8, v72, v136
    v_fmac_f32 v9, v72, v137
    v_fmac_f32 v10, v72, v138
    v_fmac_f32 v11, v72, v139
    v_fmac_f32 v8, v76, v140
    v_fmac_f32 v9, v76, v141
    v_fmac_f32 v10, v76, v142
    v_fmac_f32 v11, v76, v143
    v_cmp_eq_u32 vcc, s34, v0
    v_sub_f32 v8, v8, v5
    v_sub_f32 v9, v9, v5
    v_sub_f32 v10, v10, v5
    v_sub_f32 v11, v11, v5
    v_cndmask_b32 v12, v12, v3, vcc
    v_cndmask_b32 v13, v13, v4, vcc
    s_cmp_eq_u32 s34, 31
    s_cbranch_scc1 L_clast
    ds_write_b128 v150, v[8:11]
    s_add_u32 s35, s35, 4
    s_mov_b32 s34, s31
    v_add_u32 v150, 768, v150
    s_cmp_lt_u32 s34, 31
    s_cbranch_scc1 L_cw
    v_lshlrev_b32 v1, 4, v0
    v_add_u32 v2, 116992, v1
    ds_read_b128 v[16:19], v2 offset:0
    ds_read_b128 v[20:23], v2 offset:1024
    ds_read_b128 v[24:27], v2 offset:2048
    ds_read_b128 v[28:31], v2 offset:3072
    ds_read_b128 v[32:35], v2 offset:4096
    ds_read_b128 v[36:39], v2 offset:5120
    ds_read_b128 v[40:43], v2 offset:6144
    ds_read_b128 v[44:47], v2 offset:7168
    ds_read_b128 v[48:51], v2 offset:8192
    ds_read_b128 v[52:55], v2 offset:9216
    ds_read_b128 v[56:59], v2 offset:10240
    ds_read_b128 v[60:63], v2 offset:11264
    ds_read_b128 v[64:67], v2 offset:12288
    ds_read_b128 v[68:71], v2 offset:13312
    ds_read_b128 v[72:75], v2 offset:14336
    ds_read_b128 v[76:79], v2 offset:15360
    ds_read_b128 v[80:83], v2 offset:16384
    ds_read_b128 v[84:87], v2 offset:17408
    ds_read_b128 v[88:91], v2 offset:18432
    ds_read_b128 v[92:95], v2 offset:19456
    ds_read_b128 v[96:99], v2 offset:20480
    ds_read_b128 v[100:103], v2 offset:21504
    ds_read_b128 v[104:107], v2 offset:22528
    ds_read_b128 v[108:111], v2 offset:23552
L_cd:
    ds_read_b32 v5, v6
    s_waitcnt lgkmcnt(0)
    v_readlane_b32 s36, v5, 0
    v_readlane_b32 s37, v5, 1
    s_min_u32 s36, s36, s37
    v_readlane_b32 s37, v5, 2
    s_min_u32 s36, s36, s37
    v_readlane_b32 s37, v5, 3
    s_min_u32 s36, s36, s37
    s_cmp_lt_u32 s36, 255
    s_cbranch_scc1 L_cd
    s_mov_b32 s30, s33
    buffer_store_dwordx4 v[16:19], v1, s[20:23], s30 offen offset:0
    buffer_store_dwordx4 v[20:23], v1, s[20:23], s30 offen offset:1024
    buffer_store_dwordx4 v[24:27], v1, s[20:23], s30 offen offset:2048
    buffer_store_dwordx4 v[28:31], v1, s[20:23], s30 offen offset:3072
    s_add_u32 s30, s30, 4096
    buffer_store_dwordx4 v[32:35], v1, s[20:23], s30 offen offset:0
    buffer_store_dwordx4 v[36:39], v1, s[20:23], s30 offen offset:1024
    buffer_store_dwordx4 v[40:43], v1, s[20:23], s30 offen offset:2048
    buffer_store_dwordx4 v[44:47], v1, s[20:23], s30 offen offset:3072
    s_add_u32 s30, s30, 4096
    buffer_store_dwordx4 v[48:51], v1, s[20:23], s30 offen offset:0
    buffer_store_dwordx4 v[52:55], v1, s[20:23], s30 offen offset:1024
    buffer_store_dwordx4 v[56:59], v1, s[20:23], s30 offen offset:2048
    buffer_store_dwordx4 v[60:63], v1, s[20:23], s30 offen offset:3072
    s_add_u32 s30, s30, 4096
    buffer_store_dwordx4 v[64:67], v1, s[20:23], s30 offen offset:0
    buffer_store_dwordx4 v[68:71], v1, s[20:23], s30 offen offset:1024
    buffer_store_dwordx4 v[72:75], v1, s[20:23], s30 offen offset:2048
    buffer_store_dwordx4 v[76:79], v1, s[20:23], s30 offen offset:3072
    s_add_u32 s30, s30, 4096
    buffer_store_dwordx4 v[80:83], v1, s[20:23], s30 offen offset:0
    buffer_store_dwordx4 v[84:87], v1, s[20:23], s30 offen offset:1024
    buffer_store_dwordx4 v[88:91], v1, s[20:23], s30 offen offset:2048
    buffer_store_dwordx4 v[92:95], v1, s[20:23], s30 offen offset:3072
    s_add_u32 s30, s30, 4096
    buffer_store_dwordx4 v[96:99], v1, s[20:23], s30 offen offset:0
    buffer_store_dwordx4 v[100:103], v1, s[20:23], s30 offen offset:1024
    buffer_store_dwordx4 v[104:107], v1, s[20:23], s30 offen offset:2048
    s_mov_b64 exec, 0xffff
    buffer_store_dwordx4 v[108:111], v1, s[20:23], s30 offen offset:3072
    s_add_u32 s30, s30, 4096
    s_mov_b64 exec, -1
    s_nop 4
    s_branch L_cw
L_clast:
    s_add_u32 s33, s33, 23808
    s_mov_b32 exec_hi, 0xffff
    buffer_store_dwordx4 v[8:11], v7, s[20:23], s33 offen
    v_lshlrev_b32 v1, 3, v0
    s_lshl_b32 s30, s2, 8
    s_add_u32 s30, s30, 6291456
    s_mov_b32 exec_hi, 0
    buffer_store_dwordx2 v[12:13], v1, s[20:23], s30 offen
    s_waitcnt vmcnt(0)
    s_endpgm
L_helper:
    s_getreg_b32 s31, hwreg(HW_REG_XCC_ID, 0, 3)
    v_min_u32 v1, 3, v0
    v_lshlrev_b32 v1, 8, v1
    v_add_u32 v1, 50176, v1
    v_mov_b32 v2, 51200
    v_mov_b32 v4, 0
    s_lshl_b32 s31, s31, 12
    s_add_u32 s31, s31, 8388608
    s_mov_b32 s20, s82
    s_and_b32 s21, s83, 0xffff
    s_mov_b32 s22, 8421376
    s_mov_b32 s23, 0x20000
    s_lshr_b32 s33, s2, 3
    s_lshl_b32 s33, s33, 2
    s_add_u32 s33, s33, s31
    v_min_u32 v3, 32, v0
    v_lshlrev_b32 v3, 2, v3
    s_mov_b64 exec, 1
    buffer_store_dword v4, off, s[20:23], s33
    s_mov_b64 exec, -1
    s_barrier
    s_mov_b32 s35, 0
    s_mov_b32 s39, 0
L_hloop:
    ds_read_b32 v5, v1
    s_add_u32 s39, s39, 1
    s_cmp_ge_u32 s39, 0x40000
    s_cbranch_scc1 L_hend
    s_waitcnt lgkmcnt(0)
    v_readlane_b32 s36, v5, 0
    v_readlane_b32 s37, v5, 1
    s_add_u32 s36, s36, s37
    v_readlane_b32 s37, v5, 2
    s_add_u32 s36, s36, s37
    v_readlane_b32 s37, v5, 3
    s_add_u32 s36, s36, s37
    s_lshr_b32 s38, s36, 2
    s_cmp_lt_u32 s38, s35
    s_cbranch_scc1 L_hloop
    s_cmp_ge_u32 s38, 252
    s_cbranch_scc1 L_hend
    s_add_u32 s35, s38, 2
    s_min_u32 s35, s35, 252
    v_mov_b32 v4, s36
    s_mov_b64 exec, 1
    buffer_store_dword v4, off, s[20:23], s33
    s_mov_b64 exec, -1
    buffer_load_dword v6, v3, s[20:23], s31 offen nt
    s_waitcnt vmcnt(0)
    v_min_u32 v6, 1024, v6
    s_nop 1
    v_readlane_b32 s43, v6, 32
    v_add_u32_dpp v6, v6, v6 row_ror:8 row_mask:0xf bank_mask:0xf
    s_nop 1
    v_add_u32_dpp v6, v6, v6 row_ror:4 row_mask:0xf bank_mask:0xf
    s_nop 1
    v_add_u32_dpp v6, v6, v6 row_ror:2 row_mask:0xf bank_mask:0xf
    s_nop 1
    v_add_u32_dpp v6, v6, v6 row_ror:1 row_mask:0xf bank_mask:0xf
    s_nop 1
    v_readlane_b32 s37, v6, 0
    v_readlane_b32 s38, v6, 16
    s_add_u32 s37, s37, s38
    v_mov_b32 v5, s37
    s_lshr_b32 s37, s37, 5
    s_min_u32 s43, s43, 3
    s_sub_u32 s37, s37, s43
    v_mov_b32 v4, s37
    ds_write_b64 v2, v[4:5]
    s_branch L_hloop
L_hend:
    v_mov_b32 v4, 1073741823
    v_mov_b32 v5, 1073741823
    ds_write_b64 v2, v[4:5]
    s_waitcnt vmcnt(0) lgkmcnt(0)
    s_endpgm
L_lead:
    s_cmp_ge_u32 s2, 8
    s_cbranch_scc1 L_lend
    v_mov_b32 v2, 51200
    v_mov_b32 v4, 0
    s_mov_b32 s20, s82
    s_and_b32 s21, s83, 0xffff
    s_mov_b32 s22, 8425472
    s_mov_b32 s23, 0x20000
    s_getreg_b32 s40, hwreg(HW_REG_XCC_ID, 0, 3)
    s_lshl_b32 s31, s40, 12
    s_add_u32 s31, s31, 8388608
    s_mul_i32 s40, s40, 256
    s_add_u32 s40, s40, 8421376
    s_mov_b32 s41, 8421376
    v_and_b32 v7, 7, v0
    v_mul_u32_u24 v7, 256, v7
    s_mov_b32 s42, 1024
    s_mov_b32 s46, 0
    s_mov_b32 s39, 0
    s_mov_b64 exec, 1
    buffer_store_dword v4, off, s[20:23], s40 sc1
    buffer_store_dword v4, off, s[20:23], s31 offset:128
    s_mov_b64 exec, -1
    s_barrier
L_lp:
    ds_read_b32 v5, v2 offset:4
    s_add_u32 s39, s39, 1
    s_cmp_ge_u32 s39, 0x40000
    s_cbranch_scc1 L_lend
    s_waitcnt lgkmcnt(0)
    v_readfirstlane_b32 s47, v5
    s_cmp_lt_u32 s47, s42
    s_cbranch_scc1 L_lp
    v_mov_b32 v4, s47
    s_mov_b64 exec, 1
    buffer_store_dword v4, off, s[20:23], s40 sc1
    s_mov_b64 exec, -1
    s_add_u32 s44, s42, 384
L_lc:
    ds_read_b32 v5, v2 offset:4
    s_add_u32 s39, s39, 1
    s_cmp_ge_u32 s39, 0x40000
    s_cbranch_scc1 L_lend
    s_waitcnt lgkmcnt(0)
    v_readfirstlane_b32 s47, v5
    s_cmp_lt_u32 s47, s44
    s_cbranch_scc1 L_lc
    buffer_load_dword v10, v7, s[20:23], s41 offen sc1
    s_waitcnt vmcnt(0)
    v_cmp_gt_u32 vcc, s42, v10
    s_nop 4
    s_and_b32 s48, vcc_lo, 0xff
    s_bcnt1_i32_b32 s48, s48
    s_add_u32 s49, s46, 2
    s_min_u32 s49, s49, 3
    s_sub_i32 s46, s46, 2
    s_max_i32 s46, s46, 0
    s_cmp_ge_u32 s48, 1
    s_cselect_b32 s46, s49, s46
    v_mov_b32 v4, s46
    s_mov_b64 exec, 1
    buffer_store_dword v4, off, s[20:23], s31 offset:128
    s_mov_b64 exec, -1
    s_add_u32 s42, s42, 1024
    s_cmp_le_u32 s42, 29696
    s_cbranch_scc1 L_lp
L_lend:
    s_waitcnt vmcnt(0) lgkmcnt(0)
    s_endpgm
.globl combine_kernel
.p2align 8
.type combine_kernel,@function
combine_kernel:
    s_cmp_ge_u32 s2, 192
    s_cbranch_scc1 L_end2
    s_load_dwordx2 s[8:9], s[0:1], 56
    s_load_dwordx2 s[10:11], s[0:1], 72
    s_mul_i32 s4, s2, 43691
    s_lshr_b32 s4, s4, 18
    s_mul_i32 s5, s4, 6
    s_sub_u32 s5, s2, s5
    v_lshlrev_b32 v1, 8, v0
    v_lshrrev_b32 v4, 3, v0
    v_and_b32 v5, 7, v0
    v_mul_u32_u24 v6, 196608, v4
    v_lshl_add_u32 v6, v5, 4, v6
    s_lshl_b32 s30, s4, 3
    s_add_u32 s30, s30, 6291456
    s_mul_i32 s31, s4, 768
    s_lshl_b32 s33, s5, 7
    s_add_u32 s60, s31, s33
    s_add_u32 s61, s60, 24576
    s_add_u32 s62, s60, 49152
    s_add_u32 s63, s60, 73728
    s_add_u32 s64, s60, 98304
    s_add_u32 s65, s60, 122880
    s_add_u32 s66, s60, 147456
    s_add_u32 s67, s60, 172032
    v_lshrrev_b32 v7, 6, v0
    v_lshlrev_b32 v7, 2, v7
    v_lshlrev_b32 v8, 2, v0
    v_lshlrev_b32 v9, 5, v4
    v_mov_b32 v10, 0
    s_waitcnt lgkmcnt(0)
    s_mov_b32 s20, s10
    s_and_b32 s21, s11, 0xffff
    s_mov_b32 s22, 6356992
    s_mov_b32 s23, 0x20000
    buffer_load_dwordx2 v[2:3], v1, s[20:23], s30 offen
    buffer_load_dwordx4 v[32:35], v6, s[20:23], s60 offen
    buffer_load_dwordx4 v[36:39], v6, s[20:23], s61 offen
    buffer_load_dwordx4 v[40:43], v6, s[20:23], s62 offen
    buffer_load_dwordx4 v[44:47], v6, s[20:23], s63 offen
    buffer_load_dwordx4 v[48:51], v6, s[20:23], s64 offen
    buffer_load_dwordx4 v[52:55], v6, s[20:23], s65 offen
    buffer_load_dwordx4 v[56:59], v6, s[20:23], s66 offen
    buffer_load_dwordx4 v[60:63], v6, s[20:23], s67 offen
    s_mov_b32 s52, s8
    s_and_b32 s53, s9, 0xffff
    s_mov_b32 s54, 12288
    s_mov_b32 s55, 0x20000
    s_waitcnt vmcnt(8)
    v_mov_b32 v11, v2
    s_nop 1
    v_max_f32_dpp v11, v11, v11 row_ror:8 row_mask:0xf bank_mask:0xf
    s_nop 1
    v_max_f32_dpp v11, v11, v11 row_ror:4 row_mask:0xf bank_mask:0xf
    s_nop 1
    v_max_f32_dpp v11, v11, v11 row_ror:2 row_mask:0xf bank_mask:0xf
    s_nop 1
    v_max_f32_dpp v11, v11, v11 row_ror:1 row_mask:0xf bank_mask:0xf
    s_nop 1
    v_readlane_b32 s40, v11, 0
    v_readlane_b32 s41, v11, 16
    v_readlane_b32 s42, v11, 32
    v_readlane_b32 s43, v11, 48
    v_mov_b32 v11, s40
    v_max_f32 v11, s41, v11
    v_max_f32 v11, s42, v11
    v_max_f32 v11, s43, v11
    ds_write_b32 v7, v11 offset:3072
    s_waitcnt lgkmcnt(0)
    s_barrier
    ds_read_b128 v[12:15], v10 offset:3072
    s_waitcnt lgkmcnt(0)
    v_max_f32 v12, v12, v13
    v_max3_f32 v12, v12, v14, v15
    v_sub_f32 v2, v2, v12
    v_exp_f32 v2, v2
    s_nop 0
    v_mul_f32 v11, v2, v3
    ds_write_b32 v8, v2
    s_nop 1
    v_add_f32_dpp v11, v11, v11 row_ror:8 row_mask:0xf bank_mask:0xf
    s_nop 1
    v_add_f32_dpp v11, v11, v11 row_ror:4 row_mask:0xf bank_mask:0xf
    s_nop 1
    v_add_f32_dpp v11, v11, v11 row_ror:2 row_mask:0xf bank_mask:0xf
    s_nop 1
    v_add_f32_dpp v11, v11, v11 row_ror:1 row_mask:0xf bank_mask:0xf
    s_nop 1
    v_readlane_b32 s40, v11, 0
    v_readlane_b32 s41, v11, 16
    v_readlane_b32 s42, v11, 32
    v_readlane_b32 s43, v11, 48
    v_mov_b32 v11, s40
    v_add_f32 v11, s41, v11
    v_add_f32 v11, s42, v11
    v_add_f32 v11, s43, v11
    ds_write_b32 v7, v11 offset:3088
    s_waitcnt lgkmcnt(0)
    s_barrier
    ds_read_b128 v[16:19], v9
    ds_read_b128 v[20:23], v9 offset:16
    ds_read_b128 v[12:15], v10 offset:3088
    v_lshrrev_b32 v1, 4, v0
    v_lshlrev_b32 v1, 7, v1
    v_lshl_add_u32 v1, v5, 4, v1
    s_waitcnt vmcnt(0) lgkmcnt(0)
    v_mul_f32 v24, v16, v32
    v_mul_f32 v25, v16, v33
    v_mul_f32 v26, v16, v34
    v_mul_f32 v27, v16, v35
    v_fmac_f32 v24, v17, v36
    v_fmac_f32 v25, v17, v37
    v_fmac_f32 v26, v17, v38
    v_fmac_f32 v27, v17, v39
    v_fmac_f32 v24, v18, v40
    v_fmac_f32 v25, v18, v41
    v_fmac_f32 v26, v18, v42
    v_fmac_f32 v27, v18, v43
    v_fmac_f32 v24, v19, v44
    v_fmac_f32 v25, v19, v45
    v_fmac_f32 v26, v19, v46
    v_fmac_f32 v27, v19, v47
    v_fmac_f32 v24, v20, v48
    v_fmac_f32 v25, v20, v49
    v_fmac_f32 v26, v20, v50
    v_fmac_f32 v27, v20, v51
    v_fmac_f32 v24, v21, v52
    v_fmac_f32 v25, v21, v53
    v_fmac_f32 v26, v21, v54
    v_fmac_f32 v27, v21, v55
    v_fmac_f32 v24, v22, v56
    v_fmac_f32 v25, v22, v57
    v_fmac_f32 v26, v22, v58
    v_fmac_f32 v27, v22, v59
    v_fmac_f32 v24, v23, v60
    v_fmac_f32 v25, v23, v61
    v_fmac_f32 v26, v23, v62
    v_fmac_f32 v27, v23, v63
    v_add_f32 v12, v12, v13
    v_add_f32 v14, v14, v15
    v_add_f32_dpp v24, v24, v24 row_ror:8 row_mask:0xf bank_mask:0xf
    v_add_f32_dpp v25, v25, v25 row_ror:8 row_mask:0xf bank_mask:0xf
    v_add_f32_dpp v26, v26, v26 row_ror:8 row_mask:0xf bank_mask:0xf
    v_add_f32_dpp v27, v27, v27 row_ror:8 row_mask:0xf bank_mask:0xf
    v_add_f32 v12, v12, v14
    v_rcp_f32 v12, v12
    ds_write_b128 v1, v[24:27] offset:1024
    s_waitcnt lgkmcnt(0)
    s_barrier
    v_cmp_gt_u32 vcc, 8, v0
    s_and_b64 exec, exec, vcc
    s_cbranch_execz L_end2
    ds_read_b128 v[32:35], v1 offset:1024
    ds_read_b128 v[36:39], v1 offset:1152
    ds_read_b128 v[40:43], v1 offset:1280
    ds_read_b128 v[44:47], v1 offset:1408
    ds_read_b128 v[48:51], v1 offset:1536
    ds_read_b128 v[52:55], v1 offset:1664
    ds_read_b128 v[56:59], v1 offset:1792
    ds_read_b128 v[60:63], v1 offset:1920
    ds_read_b128 v[64:67], v1 offset:2048
    ds_read_b128 v[68:71], v1 offset:2176
    ds_read_b128 v[72:75], v1 offset:2304
    ds_read_b128 v[76:79], v1 offset:2432
    ds_read_b128 v[80:83], v1 offset:2560
    ds_read_b128 v[84:87], v1 offset:2688
    ds_read_b128 v[88:91], v1 offset:2816
    ds_read_b128 v[92:95], v1 offset:2944
    s_mul_i32 s30, s4, 384
    s_lshl_b32 s31, s5, 6
    s_add_u32 s30, s30, s31
    v_lshlrev_b32 v2, 3, v0
    s_waitcnt lgkmcnt(0)
    v_add_f32 v32, v32, v64
    v_add_f32 v33, v33, v65
    v_add_f32 v34, v34, v66
    v_add_f32 v35, v35, v67
    v_add_f32 v36, v36, v68
    v_add_f32 v37, v37, v69
    v_add_f32 v38, v38, v70
    v_add_f32 v39, v39, v71
    v_add_f32 v40, v40, v72
    v_add_f32 v41, v41, v73
    v_add_f32 v42, v42, v74
    v_add_f32 v43, v43, v75
    v_add_f32 v44, v44, v76
    v_add_f32 v45, v45, v77
    v_add_f32 v46, v46, v78
    v_add_f32 v47, v47, v79
    v_add_f32 v48, v48, v80
    v_add_f32 v49, v49, v81
    v_add_f32 v50, v50, v82
    v_add_f32 v51, v51, v83
    v_add_f32 v52, v52, v84
    v_add_f32 v53, v53, v85
    v_add_f32 v54, v54, v86
    v_add_f32 v55, v55, v87
    v_add_f32 v56, v56, v88
    v_add_f32 v57, v57, v89
    v_add_f32 v58, v58, v90
    v_add_f32 v59, v59, v91
    v_add_f32 v60, v60, v92
    v_add_f32 v61, v61, v93
    v_add_f32 v62, v62, v94
    v_add_f32 v63, v63, v95
    v_add_f32 v32, v32, v48
    v_add_f32 v33, v33, v49
    v_add_f32 v34, v34, v50
    v_add_f32 v35, v35, v51
    v_add_f32 v36, v36, v52
    v_add_f32 v37, v37, v53
    v_add_f32 v38, v38, v54
    v_add_f32 v39, v39, v55
    v_add_f32 v40, v40, v56
    v_add_f32 v41, v41, v57
    v_add_f32 v42, v42, v58
    v_add_f32 v43, v43, v59
    v_add_f32 v44, v44, v60
    v_add_f32 v45, v45, v61
    v_add_f32 v46, v46, v62
    v_add_f32 v47, v47, v63
    v_add_f32 v32, v32, v40
    v_add_f32 v33, v33, v41
    v_add_f32 v34, v34, v42
    v_add_f32 v35, v35, v43
    v_add_f32 v36, v36, v44
    v_add_f32 v37, v37, v45
    v_add_f32 v38, v38, v46
    v_add_f32 v39, v39, v47
    v_add_f32 v32, v32, v36
    v_add_f32 v33, v33, v37
    v_add_f32 v34, v34, v38
    v_add_f32 v35, v35, v39
    v_mul_f32 v32, v32, v12
    v_mul_f32 v33, v33, v12
    v_mul_f32 v34, v34, v12
    v_mul_f32 v35, v35, v12
    v_cvt_pk_bf16_f32 v32, v32, v33
    v_cvt_pk_bf16_f32 v33, v34, v35
    buffer_store_dwordx2 v[32:33], v2, s[52:55], s30 offen nt
L_end2:
    s_endpgm
.section .rodata,"a"
.p2align 6
.amdhsa_kernel standalone__kv_cache_quant_int4_int2_kv_with_per_channel_or_per_token_scales__decode_kernel
  .amdhsa_next_free_vgpr 152
  .amdhsa_next_free_sgpr 90
  .amdhsa_accum_offset 152
  .amdhsa_group_segment_fixed_size 0
  .amdhsa_kernarg_size 80
  .amdhsa_user_sgpr_count 2
  .amdhsa_user_sgpr_kernarg_segment_ptr 1
  .amdhsa_system_sgpr_workgroup_id_x 1
.end_amdhsa_kernel
.p2align 6
.amdhsa_kernel combine_kernel
  .amdhsa_next_free_vgpr 96
  .amdhsa_next_free_sgpr 90
  .amdhsa_accum_offset 96
  .amdhsa_group_segment_fixed_size 0
  .amdhsa_kernarg_size 80
  .amdhsa_user_sgpr_count 2
  .amdhsa_user_sgpr_kernarg_segment_ptr 1
  .amdhsa_system_sgpr_workgroup_id_x 1
.end_amdhsa_kernel
```
